```python
import torch

def _softmax(x, axis=-1):
    return torch.softmax(x, dim=axis)
def _gelu(x):
    return torch.nn.functional.gelu(x, approximate="tanh")
def _silu(x):
    return torch.nn.functional.silu(x)
def _sigmoid(x):
    return torch.sigmoid(x)
def _layernorm(x, axis=-1, eps=1e-5):
    m = x.mean(dim=axis, keepdim=True)
    v = x.var(dim=axis, keepdim=True, unbiased=False)
    return (x - m) / torch.sqrt(v + eps)
def _scatter_add(tgt, idx, src, axis=0):
    return tgt.clone().index_add_(axis, idx, src)
def _segment_sum(src, seg, n):
    out = torch.zeros((n,) + src.shape[1:], dtype=src.dtype)
    return out.index_add_(0, seg, src)
def _pad(x, pw):
    flat = tuple(v for pair in reversed(pw) for v in pair)
    return torch.nn.functional.pad(x, flat)

kernel_name = 'interleave_layers__spectral_gfnet__dense_activation_gelu__prompt'

def setup_inputs():

    _w = (lambda a: (lambda t: t.to(torch.bfloat16) if t.is_floating_point() else t)(torch.as_tensor(a)))
    def _A_setup():
        B, S, D = 1, 2048, 640
        Df = D // 2 + 1
        return {
            "x": _w((lambda *s: torch.randn(*s, dtype=torch.bfloat16) * 0.05)(B, S, D)),
            "w_r": _w((lambda *s: torch.randn(*s, dtype=torch.bfloat16) * 0.4)(S, Df) * 0.02),
            "w_i": _w((lambda *s: torch.randn(*s, dtype=torch.bfloat16) * 0.4)(S, Df) * 0.02),
        }
    _A_in = _A_setup()

    def _B_setup():
        B, S, D, F = 1, 2048, 640, 1728
        return {
            "x": _w((lambda *s: torch.randn(*s, dtype=torch.bfloat16) * 0.05)(B, S, D)),
            "w1": _w((lambda *s: torch.randn(*s, dtype=torch.bfloat16) * 0.4)(D, F) * (D ** -0.5)),
            "b1": _w((lambda *s: torch.randn(*s, dtype=torch.bfloat16) * 12.8)(F) * 0.01),
            "w2": _w((lambda *s: torch.randn(*s, dtype=torch.bfloat16) * 0.1)(F, D) * (F ** -0.5)),
            "b2": _w((lambda *s: torch.randn(*s, dtype=torch.bfloat16) * 0.8)(D) * 0.01),
        }
    _B_in = _B_setup()

    return {
        "A_x": _A_in["x"],
        "A_w_r": _A_in["w_r"],
        "A_w_i": _A_in["w_i"],
        "B_x": _B_in["x"],
        "B_w1": _B_in["w1"],
        "B_b1": _B_in["b1"],
        "B_w2": _B_in["w2"],
        "B_b2": _B_in["b2"],
    }

def reference(A_x, A_w_r, A_w_i, B_x, B_w1, B_b1, B_w2, B_b2):
    def _A_ref(x, w_r, w_i):
        B, S, D = x.shape
        X = (lambda x, axes=(-2,-1): torch.fft.rfft2(x.float(), dim=axes))(x, axes=(-2, -1))
        W = w_r + 1j * w_i
        X = X * W
        y = (lambda x, s, axes=(-2,-1): torch.fft.irfft2(x, s=s, dim=axes).to(torch.bfloat16))(X, (S, D), axes=(-2, -1))
        return y

    def _B_ref(x, w1, b1, w2, b2):
        h = torch.einsum("bsd,df->bsf", x, w1) + b1
        h = _gelu(h)
        return torch.einsum("bsf,fd->bsd", h, w2) + b2

    x = A_x
    x = x + _A_ref(_layernorm(x, axis=-1), A_w_r, A_w_i)
    x = x + _B_ref(_layernorm(x, axis=-1), B_w1, B_b1, B_w2, B_b2)
    x = x + _A_ref(_layernorm(x, axis=-1), A_w_r, A_w_i)
    x = x + _B_ref(_layernorm(x, axis=-1), B_w1, B_b1, B_w2, B_b2)
    return x
```

```asm
; @launch kernel=prep_kernel grid=(5152,1,1) block=(256,1,1) lds=0
; @launch kernel=ln0_kernel grid=(512,1,1) block=(256,1,1) lds=0
; @launch kernel=dft_kernel grid=(224,1,1) block=(256,1,1) lds=51200
; @launch kernel=col_kernel grid=(84,1,1) block=(512,1,1) lds=71680
; @launch kernel=idft0_kernel grid=(160,1,1) block=(512,1,1) lds=61440
; @launch kernel=ln1_kernel grid=(512,1,1) block=(256,1,1) lds=0
; @launch kernel=g1_kernel grid=(432,1,1) block=(512,1,1) lds=61440
; @launch kernel=g2a_kernel grid=(160,1,1) block=(512,1,1) lds=61440
; @launch kernel=ln2_kernel grid=(512,1,1) block=(256,1,1) lds=0
; @launch kernel=dft_kernel grid=(224,1,1) block=(256,1,1) lds=51200
; @launch kernel=col_kernel grid=(84,1,1) block=(512,1,1) lds=71680
; @launch kernel=idft1_kernel grid=(160,1,1) block=(512,1,1) lds=61440
; @launch kernel=ln1_kernel grid=(512,1,1) block=(256,1,1) lds=0
; @launch kernel=g1_kernel grid=(432,1,1) block=(512,1,1) lds=61440
; @launch kernel=g2b_kernel grid=(160,1,1) block=(512,1,1) lds=61440
.amdgcn_target "amdgcn-amd-amdhsa--gfx950"
.text
.globl prep_kernel
.p2align 8
.type prep_kernel,@function
prep_kernel:
    s_load_dwordx4 s[4:7], s[0:1], 0
    s_load_dwordx2 s[8:9], s[0:1], 16
    s_load_dwordx4 s[12:15], s[0:1], 32
    s_load_dwordx4 s[16:19], s[0:1], 48
    s_load_dwordx2 s[20:21], s[0:1], 64
    s_load_dwordx2 s[24:25], s[0:1], 80
    s_waitcnt lgkmcnt(0)
    s_add_u32 s28, s24, 0
    s_addc_u32 s29, s25, 0
    s_mov_b32 s30, 35651584
    s_mov_b32 s31, 0x00020000
    s_lshl_b32 s3, s2, 8
    v_add_u32 v1, s3, v0
    s_cmp_ge_u32 s2, 540
    s_cbranch_scc1 P_b
    v_subrev_u32 v1, 0, v1
    s_mov_b32 s40, 2485514
    v_mul_hi_u32 v2, v1, s40
    s_mov_b32 s40, 1728
    v_mul_lo_u32 v3, v2, s40
    v_sub_u32 v3, v1, v3
    s_mov_b32 s40, 27648
    v_mul_lo_u32 v4, v2, s40
    v_lshl_add_u32 v4, v3, 1, v4
    s_add_u32 s32, s12, 0
    s_addc_u32 s33, s13, 0
    s_mov_b32 s34, 2211840
    s_mov_b32 s35, 0x00020000
    buffer_load_ushort v8, v4, s[32:35], 0 offen
    v_add_u32 v4, 3456, v4
    buffer_load_ushort v9, v4, s[32:35], 0 offen
    v_add_u32 v4, 3456, v4
    buffer_load_ushort v10, v4, s[32:35], 0 offen
    v_add_u32 v4, 3456, v4
    buffer_load_ushort v11, v4, s[32:35], 0 offen
    v_add_u32 v4, 3456, v4
    buffer_load_ushort v12, v4, s[32:35], 0 offen
    v_add_u32 v4, 3456, v4
    buffer_load_ushort v13, v4, s[32:35], 0 offen
    v_add_u32 v4, 3456, v4
    buffer_load_ushort v14, v4, s[32:35], 0 offen
    v_add_u32 v4, 3456, v4
    buffer_load_ushort v15, v4, s[32:35], 0 offen
    v_add_u32 v4, 3456, v4
    s_mov_b32 s40, 1280
    v_mul_lo_u32 v1, v3, s40
    v_lshl_add_u32 v1, v2, 4, v1
    v_add_u32 v1, 0, v1
    s_waitcnt vmcnt(0)
    v_lshl_or_b32 v8, v9, 16, v8
    v_lshl_or_b32 v9, v11, 16, v10
    v_lshl_or_b32 v10, v13, 16, v12
    v_lshl_or_b32 v11, v15, 16, v14
    buffer_store_dwordx4 v[8:11], v1, s[28:31], 0 offen
    s_branch P_end
P_b:
    s_cmp_ge_u32 s2, 1080
    s_cbranch_scc1 P_w
    v_subrev_u32 v1, 138240, v1
    s_mov_b32 s40, 6710887
    v_mul_hi_u32 v2, v1, s40
    s_mov_b32 s40, 640
    v_mul_lo_u32 v3, v2, s40
    v_sub_u32 v3, v1, v3
    s_mov_b32 s40, 10240
    v_mul_lo_u32 v4, v2, s40
    v_lshl_add_u32 v4, v3, 1, v4
    s_add_u32 s32, s16, 0
    s_addc_u32 s33, s17, 0
    s_mov_b32 s34, 2211840
    s_mov_b32 s35, 0x00020000
    buffer_load_ushort v8, v4, s[32:35], 0 offen
    v_add_u32 v4, 1280, v4
    buffer_load_ushort v9, v4, s[32:35], 0 offen
    v_add_u32 v4, 1280, v4
    buffer_load_ushort v10, v4, s[32:35], 0 offen
    v_add_u32 v4, 1280, v4
    buffer_load_ushort v11, v4, s[32:35], 0 offen
    v_add_u32 v4, 1280, v4
    buffer_load_ushort v12, v4, s[32:35], 0 offen
    v_add_u32 v4, 1280, v4
    buffer_load_ushort v13, v4, s[32:35], 0 offen
    v_add_u32 v4, 1280, v4
    buffer_load_ushort v14, v4, s[32:35], 0 offen
    v_add_u32 v4, 1280, v4
    buffer_load_ushort v15, v4, s[32:35], 0 offen
    v_add_u32 v4, 1280, v4
    s_mov_b32 s40, 3456
    v_mul_lo_u32 v1, v3, s40
    v_lshl_add_u32 v1, v2, 4, v1
    v_add_u32 v1, 2228224, v1
    s_waitcnt vmcnt(0)
    v_lshl_or_b32 v8, v9, 16, v8
    v_lshl_or_b32 v9, v11, 16, v10
    v_lshl_or_b32 v10, v13, 16, v12
    v_lshl_or_b32 v11, v15, 16, v14
    buffer_store_dwordx4 v[8:11], v1, s[28:31], 0 offen
    s_branch P_end
P_w:
    s_cmp_ge_u32 s2, 1752
    s_cbranch_scc1 P_c
    v_subrev_u32 v1, 276480, v1
    s_mov_b32 s40, 12782641
    v_mul_hi_u32 v2, v1, s40
    v_mul_u32_u24 v3, 336, v2
    v_sub_u32 v3, v1, v3
    v_bfe_u32 v4, v2, 6, 2
    v_lshlrev_b32 v4, 4, v4
    v_and_b32 v5, 15, v2
    v_add_u32 v4, v4, v5
    v_lshrrev_b32 v5, 8, v2
    v_lshlrev_b32 v5, 10, v5
    v_add_u32 v4, v4, v5
    v_bfe_u32 v5, v2, 4, 2
    v_lshl_add_u32 v4, v5, 8, v4
    v_mul_u32_u24 v4, 642, v4
    v_lshl_add_u32 v4, v3, 1, v4
    v_cmp_gt_u32 vcc, 321, v3
    s_nop 1
    v_cndmask_b32 v4, -1, v4, vcc
    s_add_u32 s32, s6, 0
    s_addc_u32 s33, s7, 0
    s_mov_b32 s34, 1314816
    s_mov_b32 s35, 0x00020000
    s_add_u32 s36, s8, 0
    s_addc_u32 s37, s9, 0
    s_mov_b32 s38, 1314816
    s_mov_b32 s39, 0x00020000
    v_add_u32 v6, 0, v4
    v_cndmask_b32 v6, v4, v6, vcc
    buffer_load_ushort v8, v6, s[32:35], 0 offen
    v_add_u32 v6, 41088, v4
    v_cndmask_b32 v6, v4, v6, vcc
    buffer_load_ushort v9, v6, s[32:35], 0 offen
    v_add_u32 v6, 82176, v4
    v_cndmask_b32 v6, v4, v6, vcc
    buffer_load_ushort v10, v6, s[32:35], 0 offen
    v_add_u32 v6, 123264, v4
    v_cndmask_b32 v6, v4, v6, vcc
    buffer_load_ushort v11, v6, s[32:35], 0 offen
    v_add_u32 v6, 0, v4
    v_cndmask_b32 v6, v4, v6, vcc
    buffer_load_ushort v12, v6, s[36:39], 0 offen
    v_add_u32 v6, 41088, v4
    v_cndmask_b32 v6, v4, v6, vcc
    buffer_load_ushort v13, v6, s[36:39], 0 offen
    v_add_u32 v6, 82176, v4
    v_cndmask_b32 v6, v4, v6, vcc
    buffer_load_ushort v14, v6, s[36:39], 0 offen
    v_add_u32 v6, 123264, v4
    v_cndmask_b32 v6, v4, v6, vcc
    buffer_load_ushort v15, v6, s[36:39], 0 offen
    v_lshlrev_b32 v1, 13, v3
    v_lshl_add_u32 v1, v2, 4, v1
    v_add_u32 v1, 31457280, v1
    s_waitcnt vmcnt(0)
    v_lshl_or_b32 v8, v9, 16, v8
    v_lshl_or_b32 v9, v11, 16, v10
    v_lshl_or_b32 v10, v13, 16, v12
    v_lshl_or_b32 v11, v15, 16, v14
    buffer_store_dwordx4 v[8:11], v1, s[28:31], 0 offen
    s_branch P_end
P_c:
    s_cmp_ge_u32 s2, 3432
    s_cbranch_scc1 P_d
    v_subrev_u32 v1, 448512, v1
    s_mov_b32 s40, 6710887
    v_mul_hi_u32 v2, v1, s40
    s_mov_b32 s40, 640
    v_mul_lo_u32 v3, v2, s40
    v_sub_u32 v3, v1, v3
    v_lshrrev_b32 v4, 1, v2
    v_mul_lo_u32 v6, v4, v3
    s_mov_b32 s40, 6710887
    v_mul_hi_u32 v9, v6, s40
    s_mov_b32 s40, 640
    v_mul_lo_u32 v9, v9, s40
    v_sub_u32 v6, v6, v9
    v_cvt_f32_u32 v6, v6
    v_mul_f32 v6, 0x3acccccd, v6
    v_cos_f32 v7, v6
    v_sin_f32 v8, v6
    s_nop 0
    v_sub_f32 v8, 0, v8
    v_and_b32 v5, 1, v2
    v_cmp_eq_u32 vcc, 1, v5
    s_nop 1
    v_cndmask_b32 v7, v7, v8, vcc
    v_cmp_lt_u32 vcc, 320, v4
    s_nop 1
    v_cndmask_b32 v7, v7, 0, vcc
    v_cvt_pk_bf16_f32 v7, v7, v7
    v_lshlrev_b32 v1, 1, v1
    v_add_u32 v1, 4456448, v1
    buffer_store_short v7, v1, s[28:31], 0 offen
    s_branch P_end
P_d:
    s_cmp_ge_u32 s2, 5112
    s_cbranch_scc1 P_e
    v_subrev_u32 v1, 878592, v1
    s_mov_b32 s40, 6391321
    v_mul_hi_u32 v2, v1, s40
    s_mov_b32 s40, 672
    v_mul_lo_u32 v3, v2, s40
    v_sub_u32 v3, v1, v3
    v_lshrrev_b32 v4, 3, v3
    v_and_b32 v5, 3, v3
    v_lshl_add_u32 v4, v4, 2, v5
    v_and_b32 v5, 4, v3
    v_cmp_eq_u32 vcc, 0, v5
    s_nop 1
    v_mul_lo_u32 v6, v4, v2
    s_mov_b32 s40, 6710887
    v_mul_hi_u32 v9, v6, s40
    s_mov_b32 s40, 640
    v_mul_lo_u32 v9, v9, s40
    v_sub_u32 v6, v6, v9
    v_cvt_f32_u32 v6, v6
    v_mul_f32 v6, 0x3acccccd, v6
    v_cos_f32 v7, v6
    v_sin_f32 v8, v6
    s_nop 0
    v_sub_f32 v8, 0, v8
    v_cndmask_b32 v7, v8, v7, vcc
    v_add_f32 v8, v7, v7
    v_cmp_eq_u32 vcc, 0, v4
    s_nop 1
    v_cndmask_b32 v8, v8, v7, vcc
    v_cmp_eq_u32 vcc, 320, v4
    s_nop 1
    v_cndmask_b32 v8, v8, v7, vcc
    v_cmp_lt_u32 vcc, 320, v4
    s_nop 1
    v_cndmask_b32 v8, v8, 0, vcc
    v_cvt_pk_bf16_f32 v7, v8, v8
    v_lshlrev_b32 v1, 1, v1
    v_add_u32 v1, 5373952, v1
    buffer_store_short v7, v1, s[28:31], 0 offen
    s_branch P_end
P_e:
    s_cmp_ge_u32 s2, 5152
    s_cbranch_scc1 P_end
    v_subrev_u32 v1, 1308672, v1
    v_and_b32 v2, 63, v1
    v_bfe_u32 v3, v1, 6, 6
    v_mul_lo_u32 v6, v2, v3
    v_and_b32 v6, 63, v6
    v_cvt_f32_u32 v6, v6
    v_mul_f32 v6, 0x3c800000, v6
    v_bfe_u32 v10, v1, 12, 1
    v_and_b32 v2, 31, v1
    v_bfe_u32 v3, v1, 5, 5
    v_mul_lo_u32 v7, v2, v3
    v_and_b32 v7, 31, v7
    v_cvt_f32_u32 v7, v7
    v_mul_f32 v7, 0x3d000000, v7
    v_bfe_u32 v11, v1, 10, 1
    v_cmp_lt_u32 vcc, 8191, v1
    s_nop 1
    v_cndmask_b32 v6, v6, v7, vcc
    v_cndmask_b32 v10, v10, v11, vcc
    v_cos_f32 v7, v6
    v_sin_f32 v8, v6
    v_cmp_eq_u32 vcc, 1, v10
    s_nop 1
    v_cndmask_b32 v7, v7, v8, vcc
    v_cvt_pk_bf16_f32 v7, v7, v7
    v_lshlrev_b32 v1, 1, v1
    v_add_u32 v1, 6291456, v1
    buffer_store_short v7, v1, s[28:31], 0 offen
P_end:
    s_endpgm
.section .rodata,"a"
.p2align 6
.amdhsa_kernel prep_kernel
  .amdhsa_next_free_vgpr 16
  .amdhsa_next_free_sgpr 100
  .amdhsa_accum_offset 16
  .amdhsa_group_segment_fixed_size 0
  .amdhsa_kernarg_size 88
  .amdhsa_user_sgpr_count 2
  .amdhsa_user_sgpr_kernarg_segment_ptr 1
  .amdhsa_system_sgpr_workgroup_id_x 1
.end_amdhsa_kernel
.text
.globl ln0_kernel
.p2align 8
.type ln0_kernel,@function
ln0_kernel:
    s_load_dwordx4 s[4:7], s[0:1], 0
    s_load_dwordx2 s[8:9], s[0:1], 16
    s_load_dwordx4 s[12:15], s[0:1], 32
    s_load_dwordx4 s[16:19], s[0:1], 48
    s_load_dwordx2 s[20:21], s[0:1], 64
    s_load_dwordx2 s[24:25], s[0:1], 80
    s_waitcnt lgkmcnt(0)
    s_cmp_ge_u32 s2, 512
    s_cbranch_scc1 ln0_kernel_end
    s_add_u32 s28, s4, 0
    s_addc_u32 s29, s5, 0
    s_mov_b32 s30, 2621440
    s_mov_b32 s31, 0x00020000
    s_add_u32 s32, s24, 7340032
    s_addc_u32 s33, s25, 0
    s_mov_b32 s34, 2621440
    s_mov_b32 s35, 0x00020000
    v_lshrrev_b32 v1, 6, v0
    v_and_b32 v40, 63, v0
    s_lshl_b32 s3, s2, 2
    v_add_u32 v1, s3, v1
    v_mul_u32_u24 v1, 1280, v1
    v_lshl_add_u32 v1, v40, 2, v1
    v_lshlrev_b32 v40, 2, v40
    buffer_load_dword v2, v1, s[28:31], 0 offen offset:0
    buffer_load_dword v3, v1, s[28:31], 0 offen offset:256
    buffer_load_dword v4, v1, s[28:31], 0 offen offset:512
    buffer_load_dword v5, v1, s[28:31], 0 offen offset:768
    buffer_load_dword v6, v1, s[28:31], 0 offen offset:1024
    s_waitcnt vmcnt(0)
    v_lshlrev_b32 v10, 16, v2
    v_and_b32 v11, 0xffff0000, v2
    v_lshlrev_b32 v12, 16, v3
    v_and_b32 v13, 0xffff0000, v3
    v_lshlrev_b32 v14, 16, v4
    v_and_b32 v15, 0xffff0000, v4
    v_lshlrev_b32 v16, 16, v5
    v_and_b32 v17, 0xffff0000, v5
    v_lshlrev_b32 v18, 16, v6
    v_and_b32 v19, 0xffff0000, v6
    v_mov_b32 v20, 0
    v_add_f32 v20, v20, v10
    v_add_f32 v20, v20, v11
    v_add_f32 v20, v20, v12
    v_add_f32 v20, v20, v13
    v_add_f32 v20, v20, v14
    v_add_f32 v20, v20, v15
    v_add_f32 v20, v20, v16
    v_add_f32 v20, v20, v17
    v_add_f32 v20, v20, v18
    v_add_f32 v20, v20, v19
    v_xor_b32 v21, 4, v40
    ds_bpermute_b32 v21, v21, v20
    s_waitcnt lgkmcnt(0)
    v_add_f32 v20, v20, v21
    v_xor_b32 v21, 8, v40
    ds_bpermute_b32 v21, v21, v20
    s_waitcnt lgkmcnt(0)
    v_add_f32 v20, v20, v21
    v_xor_b32 v21, 16, v40
    ds_bpermute_b32 v21, v21, v20
    s_waitcnt lgkmcnt(0)
    v_add_f32 v20, v20, v21
    v_xor_b32 v21, 32, v40
    ds_bpermute_b32 v21, v21, v20
    s_waitcnt lgkmcnt(0)
    v_add_f32 v20, v20, v21
    v_xor_b32 v21, 64, v40
    ds_bpermute_b32 v21, v21, v20
    s_waitcnt lgkmcnt(0)
    v_add_f32 v20, v20, v21
    v_xor_b32 v21, 128, v40
    ds_bpermute_b32 v21, v21, v20
    s_waitcnt lgkmcnt(0)
    v_add_f32 v20, v20, v21
    v_mul_f32 v22, 0x3acccccd, v20
    v_mov_b32 v20, 0
    v_sub_f32 v21, v10, v22
    v_fmac_f32 v20, v21, v21
    v_sub_f32 v21, v11, v22
    v_fmac_f32 v20, v21, v21
    v_sub_f32 v21, v12, v22
    v_fmac_f32 v20, v21, v21
    v_sub_f32 v21, v13, v22
    v_fmac_f32 v20, v21, v21
    v_sub_f32 v21, v14, v22
    v_fmac_f32 v20, v21, v21
    v_sub_f32 v21, v15, v22
    v_fmac_f32 v20, v21, v21
    v_sub_f32 v21, v16, v22
    v_fmac_f32 v20, v21, v21
    v_sub_f32 v21, v17, v22
    v_fmac_f32 v20, v21, v21
    v_sub_f32 v21, v18, v22
    v_fmac_f32 v20, v21, v21
    v_sub_f32 v21, v19, v22
    v_fmac_f32 v20, v21, v21
    v_xor_b32 v21, 4, v40
    ds_bpermute_b32 v21, v21, v20
    s_waitcnt lgkmcnt(0)
    v_add_f32 v20, v20, v21
    v_xor_b32 v21, 8, v40
    ds_bpermute_b32 v21, v21, v20
    s_waitcnt lgkmcnt(0)
    v_add_f32 v20, v20, v21
    v_xor_b32 v21, 16, v40
    ds_bpermute_b32 v21, v21, v20
    s_waitcnt lgkmcnt(0)
    v_add_f32 v20, v20, v21
    v_xor_b32 v21, 32, v40
    ds_bpermute_b32 v21, v21, v20
    s_waitcnt lgkmcnt(0)
    v_add_f32 v20, v20, v21
    v_xor_b32 v21, 64, v40
    ds_bpermute_b32 v21, v21, v20
    s_waitcnt lgkmcnt(0)
    v_add_f32 v20, v20, v21
    v_xor_b32 v21, 128, v40
    ds_bpermute_b32 v21, v21, v20
    s_waitcnt lgkmcnt(0)
    v_add_f32 v20, v20, v21
    v_mul_f32 v20, 0x3acccccd, v20
    v_cvt_pk_bf16_f32 v22, v22, v22
    v_lshlrev_b32 v22, 16, v22
    v_cvt_pk_bf16_f32 v20, v20, v20
    v_lshlrev_b32 v20, 16, v20
    v_add_f32 v20, 0x3727c5ac, v20
    v_cvt_pk_bf16_f32 v20, v20, v20
    v_lshlrev_b32 v20, 16, v20
    v_sqrt_f32 v20, v20
    s_nop 0
    v_cvt_pk_bf16_f32 v20, v20, v20
    v_lshlrev_b32 v20, 16, v20
    v_rcp_f32 v23, v20
    s_nop 0
    v_sub_f32 v10, v10, v22
    v_cvt_pk_bf16_f32 v10, v10, v10
    v_lshlrev_b32 v10, 16, v10
    v_mul_f32 v24, v10, v23
    v_fma_f32 v25, -v24, v20, v10
    v_fma_f32 v10, v25, v23, v24
    v_sub_f32 v11, v11, v22
    v_cvt_pk_bf16_f32 v11, v11, v11
    v_lshlrev_b32 v11, 16, v11
    v_mul_f32 v24, v11, v23
    v_fma_f32 v25, -v24, v20, v11
    v_fma_f32 v11, v25, v23, v24
    v_sub_f32 v12, v12, v22
    v_cvt_pk_bf16_f32 v12, v12, v12
    v_lshlrev_b32 v12, 16, v12
    v_mul_f32 v24, v12, v23
    v_fma_f32 v25, -v24, v20, v12
    v_fma_f32 v12, v25, v23, v24
    v_sub_f32 v13, v13, v22
    v_cvt_pk_bf16_f32 v13, v13, v13
    v_lshlrev_b32 v13, 16, v13
    v_mul_f32 v24, v13, v23
    v_fma_f32 v25, -v24, v20, v13
    v_fma_f32 v13, v25, v23, v24
    v_sub_f32 v14, v14, v22
    v_cvt_pk_bf16_f32 v14, v14, v14
    v_lshlrev_b32 v14, 16, v14
    v_mul_f32 v24, v14, v23
    v_fma_f32 v25, -v24, v20, v14
    v_fma_f32 v14, v25, v23, v24
    v_sub_f32 v15, v15, v22
    v_cvt_pk_bf16_f32 v15, v15, v15
    v_lshlrev_b32 v15, 16, v15
    v_mul_f32 v24, v15, v23
    v_fma_f32 v25, -v24, v20, v15
    v_fma_f32 v15, v25, v23, v24
    v_sub_f32 v16, v16, v22
    v_cvt_pk_bf16_f32 v16, v16, v16
    v_lshlrev_b32 v16, 16, v16
    v_mul_f32 v24, v16, v23
    v_fma_f32 v25, -v24, v20, v16
    v_fma_f32 v16, v25, v23, v24
    v_sub_f32 v17, v17, v22
    v_cvt_pk_bf16_f32 v17, v17, v17
    v_lshlrev_b32 v17, 16, v17
    v_mul_f32 v24, v17, v23
    v_fma_f32 v25, -v24, v20, v17
    v_fma_f32 v17, v25, v23, v24
    v_sub_f32 v18, v18, v22
    v_cvt_pk_bf16_f32 v18, v18, v18
    v_lshlrev_b32 v18, 16, v18
    v_mul_f32 v24, v18, v23
    v_fma_f32 v25, -v24, v20, v18
    v_fma_f32 v18, v25, v23, v24
    v_sub_f32 v19, v19, v22
    v_cvt_pk_bf16_f32 v19, v19, v19
    v_lshlrev_b32 v19, 16, v19
    v_mul_f32 v24, v19, v23
    v_fma_f32 v25, -v24, v20, v19
    v_fma_f32 v19, v25, v23, v24
    v_cvt_pk_bf16_f32 v2, v10, v11
    buffer_store_dword v2, v1, s[32:35], 0 offen offset:0
    v_cvt_pk_bf16_f32 v3, v12, v13
    buffer_store_dword v3, v1, s[32:35], 0 offen offset:256
    v_cvt_pk_bf16_f32 v4, v14, v15
    buffer_store_dword v4, v1, s[32:35], 0 offen offset:512
    v_cvt_pk_bf16_f32 v5, v16, v17
    buffer_store_dword v5, v1, s[32:35], 0 offen offset:768
    v_cvt_pk_bf16_f32 v6, v18, v19
    buffer_store_dword v6, v1, s[32:35], 0 offen offset:1024
ln0_kernel_end:
    s_endpgm
.section .rodata,"a"
.p2align 6
.amdhsa_kernel ln0_kernel
  .amdhsa_next_free_vgpr 48
  .amdhsa_next_free_sgpr 100
  .amdhsa_accum_offset 48
  .amdhsa_group_segment_fixed_size 0
  .amdhsa_kernarg_size 88
  .amdhsa_user_sgpr_count 2
  .amdhsa_user_sgpr_kernarg_segment_ptr 1
  .amdhsa_system_sgpr_workgroup_id_x 1
.end_amdhsa_kernel
.text
.globl ln1_kernel
.p2align 8
.type ln1_kernel,@function
ln1_kernel:
    s_load_dwordx4 s[4:7], s[0:1], 0
    s_load_dwordx2 s[8:9], s[0:1], 16
    s_load_dwordx4 s[12:15], s[0:1], 32
    s_load_dwordx4 s[16:19], s[0:1], 48
    s_load_dwordx2 s[20:21], s[0:1], 64
    s_load_dwordx2 s[24:25], s[0:1], 80
    s_waitcnt lgkmcnt(0)
    s_cmp_ge_u32 s2, 512
    s_cbranch_scc1 ln1_kernel_end
    s_add_u32 s28, s24, 25165824
    s_addc_u32 s29, s25, 0
    s_mov_b32 s30, 2621440
    s_mov_b32 s31, 0x00020000
    s_add_u32 s32, s24, 7340032
    s_addc_u32 s33, s25, 0
    s_mov_b32 s34, 2621440
    s_mov_b32 s35, 0x00020000
    v_lshrrev_b32 v1, 6, v0
    v_and_b32 v40, 63, v0
    s_lshl_b32 s3, s2, 2
    v_add_u32 v1, s3, v1
    v_mul_u32_u24 v1, 1280, v1
    v_lshl_add_u32 v1, v40, 2, v1
    v_lshlrev_b32 v40, 2, v40
    buffer_load_dword v2, v1, s[28:31], 0 offen offset:0
    buffer_load_dword v3, v1, s[28:31], 0 offen offset:256
    buffer_load_dword v4, v1, s[28:31], 0 offen offset:512
    buffer_load_dword v5, v1, s[28:31], 0 offen offset:768
    buffer_load_dword v6, v1, s[28:31], 0 offen offset:1024
    s_waitcnt vmcnt(0)
    v_lshlrev_b32 v10, 16, v2
    v_and_b32 v11, 0xffff0000, v2
    v_lshlrev_b32 v12, 16, v3
    v_and_b32 v13, 0xffff0000, v3
    v_lshlrev_b32 v14, 16, v4
    v_and_b32 v15, 0xffff0000, v4
    v_lshlrev_b32 v16, 16, v5
    v_and_b32 v17, 0xffff0000, v5
    v_lshlrev_b32 v18, 16, v6
    v_and_b32 v19, 0xffff0000, v6
    v_mov_b32 v20, 0
    v_add_f32 v20, v20, v10
    v_add_f32 v20, v20, v11
    v_add_f32 v20, v20, v12
    v_add_f32 v20, v20, v13
    v_add_f32 v20, v20, v14
    v_add_f32 v20, v20, v15
    v_add_f32 v20, v20, v16
    v_add_f32 v20, v20, v17
    v_add_f32 v20, v20, v18
    v_add_f32 v20, v20, v19
    v_xor_b32 v21, 4, v40
    ds_bpermute_b32 v21, v21, v20
    s_waitcnt lgkmcnt(0)
    v_add_f32 v20, v20, v21
    v_xor_b32 v21, 8, v40
    ds_bpermute_b32 v21, v21, v20
    s_waitcnt lgkmcnt(0)
    v_add_f32 v20, v20, v21
    v_xor_b32 v21, 16, v40
    ds_bpermute_b32 v21, v21, v20
    s_waitcnt lgkmcnt(0)
    v_add_f32 v20, v20, v21
    v_xor_b32 v21, 32, v40
    ds_bpermute_b32 v21, v21, v20
    s_waitcnt lgkmcnt(0)
    v_add_f32 v20, v20, v21
    v_xor_b32 v21, 64, v40
    ds_bpermute_b32 v21, v21, v20
    s_waitcnt lgkmcnt(0)
    v_add_f32 v20, v20, v21
    v_xor_b32 v21, 128, v40
    ds_bpermute_b32 v21, v21, v20
    s_waitcnt lgkmcnt(0)
    v_add_f32 v20, v20, v21
    v_mul_f32 v22, 0x3acccccd, v20
    v_mov_b32 v20, 0
    v_sub_f32 v21, v10, v22
    v_fmac_f32 v20, v21, v21
    v_sub_f32 v21, v11, v22
    v_fmac_f32 v20, v21, v21
    v_sub_f32 v21, v12, v22
    v_fmac_f32 v20, v21, v21
    v_sub_f32 v21, v13, v22
    v_fmac_f32 v20, v21, v21
    v_sub_f32 v21, v14, v22
    v_fmac_f32 v20, v21, v21
    v_sub_f32 v21, v15, v22
    v_fmac_f32 v20, v21, v21
    v_sub_f32 v21, v16, v22
    v_fmac_f32 v20, v21, v21
    v_sub_f32 v21, v17, v22
    v_fmac_f32 v20, v21, v21
    v_sub_f32 v21, v18, v22
    v_fmac_f32 v20, v21, v21
    v_sub_f32 v21, v19, v22
    v_fmac_f32 v20, v21, v21
    v_xor_b32 v21, 4, v40
    ds_bpermute_b32 v21, v21, v20
    s_waitcnt lgkmcnt(0)
    v_add_f32 v20, v20, v21
    v_xor_b32 v21, 8, v40
    ds_bpermute_b32 v21, v21, v20
    s_waitcnt lgkmcnt(0)
    v_add_f32 v20, v20, v21
    v_xor_b32 v21, 16, v40
    ds_bpermute_b32 v21, v21, v20
    s_waitcnt lgkmcnt(0)
    v_add_f32 v20, v20, v21
    v_xor_b32 v21, 32, v40
    ds_bpermute_b32 v21, v21, v20
    s_waitcnt lgkmcnt(0)
    v_add_f32 v20, v20, v21
    v_xor_b32 v21, 64, v40
    ds_bpermute_b32 v21, v21, v20
    s_waitcnt lgkmcnt(0)
    v_add_f32 v20, v20, v21
    v_xor_b32 v21, 128, v40
    ds_bpermute_b32 v21, v21, v20
    s_waitcnt lgkmcnt(0)
    v_add_f32 v20, v20, v21
    v_mul_f32 v20, 0x3acccccd, v20
    v_cvt_pk_bf16_f32 v22, v22, v22
    v_lshlrev_b32 v22, 16, v22
    v_cvt_pk_bf16_f32 v20, v20, v20
    v_lshlrev_b32 v20, 16, v20
    v_add_f32 v20, 0x3727c5ac, v20
    v_cvt_pk_bf16_f32 v20, v20, v20
    v_lshlrev_b32 v20, 16, v20
    v_sqrt_f32 v20, v20
    s_nop 0
    v_cvt_pk_bf16_f32 v20, v20, v20
    v_lshlrev_b32 v20, 16, v20
    v_rcp_f32 v23, v20
    s_nop 0
    v_sub_f32 v10, v10, v22
    v_cvt_pk_bf16_f32 v10, v10, v10
    v_lshlrev_b32 v10, 16, v10
    v_mul_f32 v24, v10, v23
    v_fma_f32 v25, -v24, v20, v10
    v_fma_f32 v10, v25, v23, v24
    v_sub_f32 v11, v11, v22
    v_cvt_pk_bf16_f32 v11, v11, v11
    v_lshlrev_b32 v11, 16, v11
    v_mul_f32 v24, v11, v23
    v_fma_f32 v25, -v24, v20, v11
    v_fma_f32 v11, v25, v23, v24
    v_sub_f32 v12, v12, v22
    v_cvt_pk_bf16_f32 v12, v12, v12
    v_lshlrev_b32 v12, 16, v12
    v_mul_f32 v24, v12, v23
    v_fma_f32 v25, -v24, v20, v12
    v_fma_f32 v12, v25, v23, v24
    v_sub_f32 v13, v13, v22
    v_cvt_pk_bf16_f32 v13, v13, v13
    v_lshlrev_b32 v13, 16, v13
    v_mul_f32 v24, v13, v23
    v_fma_f32 v25, -v24, v20, v13
    v_fma_f32 v13, v25, v23, v24
    v_sub_f32 v14, v14, v22
    v_cvt_pk_bf16_f32 v14, v14, v14
    v_lshlrev_b32 v14, 16, v14
    v_mul_f32 v24, v14, v23
    v_fma_f32 v25, -v24, v20, v14
    v_fma_f32 v14, v25, v23, v24
    v_sub_f32 v15, v15, v22
    v_cvt_pk_bf16_f32 v15, v15, v15
    v_lshlrev_b32 v15, 16, v15
    v_mul_f32 v24, v15, v23
    v_fma_f32 v25, -v24, v20, v15
    v_fma_f32 v15, v25, v23, v24
    v_sub_f32 v16, v16, v22
    v_cvt_pk_bf16_f32 v16, v16, v16
    v_lshlrev_b32 v16, 16, v16
    v_mul_f32 v24, v16, v23
    v_fma_f32 v25, -v24, v20, v16
    v_fma_f32 v16, v25, v23, v24
    v_sub_f32 v17, v17, v22
    v_cvt_pk_bf16_f32 v17, v17, v17
    v_lshlrev_b32 v17, 16, v17
    v_mul_f32 v24, v17, v23
    v_fma_f32 v25, -v24, v20, v17
    v_fma_f32 v17, v25, v23, v24
    v_sub_f32 v18, v18, v22
    v_cvt_pk_bf16_f32 v18, v18, v18
    v_lshlrev_b32 v18, 16, v18
    v_mul_f32 v24, v18, v23
    v_fma_f32 v25, -v24, v20, v18
    v_fma_f32 v18, v25, v23, v24
    v_sub_f32 v19, v19, v22
    v_cvt_pk_bf16_f32 v19, v19, v19
    v_lshlrev_b32 v19, 16, v19
    v_mul_f32 v24, v19, v23
    v_fma_f32 v25, -v24, v20, v19
    v_fma_f32 v19, v25, v23, v24
    v_cvt_pk_bf16_f32 v2, v10, v11
    buffer_store_dword v2, v1, s[32:35], 0 offen offset:0
    v_cvt_pk_bf16_f32 v3, v12, v13
    buffer_store_dword v3, v1, s[32:35], 0 offen offset:256
    v_cvt_pk_bf16_f32 v4, v14, v15
    buffer_store_dword v4, v1, s[32:35], 0 offen offset:512
    v_cvt_pk_bf16_f32 v5, v16, v17
    buffer_store_dword v5, v1, s[32:35], 0 offen offset:768
    v_cvt_pk_bf16_f32 v6, v18, v19
    buffer_store_dword v6, v1, s[32:35], 0 offen offset:1024
ln1_kernel_end:
    s_endpgm
.section .rodata,"a"
.p2align 6
.amdhsa_kernel ln1_kernel
  .amdhsa_next_free_vgpr 48
  .amdhsa_next_free_sgpr 100
  .amdhsa_accum_offset 48
  .amdhsa_group_segment_fixed_size 0
  .amdhsa_kernarg_size 88
  .amdhsa_user_sgpr_count 2
  .amdhsa_user_sgpr_kernarg_segment_ptr 1
  .amdhsa_system_sgpr_workgroup_id_x 1
.end_amdhsa_kernel
.text
.globl ln2_kernel
.p2align 8
.type ln2_kernel,@function
ln2_kernel:
    s_load_dwordx4 s[4:7], s[0:1], 0
    s_load_dwordx2 s[8:9], s[0:1], 16
    s_load_dwordx4 s[12:15], s[0:1], 32
    s_load_dwordx4 s[16:19], s[0:1], 48
    s_load_dwordx2 s[20:21], s[0:1], 64
    s_load_dwordx2 s[24:25], s[0:1], 80
    s_waitcnt lgkmcnt(0)
    s_cmp_ge_u32 s2, 512
    s_cbranch_scc1 ln2_kernel_end
    s_add_u32 s28, s24, 28311552
    s_addc_u32 s29, s25, 0
    s_mov_b32 s30, 2621440
    s_mov_b32 s31, 0x00020000
    s_add_u32 s32, s24, 7340032
    s_addc_u32 s33, s25, 0
    s_mov_b32 s34, 2621440
    s_mov_b32 s35, 0x00020000
    v_lshrrev_b32 v1, 6, v0
    v_and_b32 v40, 63, v0
    s_lshl_b32 s3, s2, 2
    v_add_u32 v1, s3, v1
    v_mul_u32_u24 v1, 1280, v1
    v_lshl_add_u32 v1, v40, 2, v1
    v_lshlrev_b32 v40, 2, v40
    buffer_load_dword v2, v1, s[28:31], 0 offen offset:0
    buffer_load_dword v3, v1, s[28:31], 0 offen offset:256
    buffer_load_dword v4, v1, s[28:31], 0 offen offset:512
    buffer_load_dword v5, v1, s[28:31], 0 offen offset:768
    buffer_load_dword v6, v1, s[28:31], 0 offen offset:1024
    s_waitcnt vmcnt(0)
    v_lshlrev_b32 v10, 16, v2
    v_and_b32 v11, 0xffff0000, v2
    v_lshlrev_b32 v12, 16, v3
    v_and_b32 v13, 0xffff0000, v3
    v_lshlrev_b32 v14, 16, v4
    v_and_b32 v15, 0xffff0000, v4
    v_lshlrev_b32 v16, 16, v5
    v_and_b32 v17, 0xffff0000, v5
    v_lshlrev_b32 v18, 16, v6
    v_and_b32 v19, 0xffff0000, v6
    v_mov_b32 v20, 0
    v_add_f32 v20, v20, v10
    v_add_f32 v20, v20, v11
    v_add_f32 v20, v20, v12
    v_add_f32 v20, v20, v13
    v_add_f32 v20, v20, v14
    v_add_f32 v20, v20, v15
    v_add_f32 v20, v20, v16
    v_add_f32 v20, v20, v17
    v_add_f32 v20, v20, v18
    v_add_f32 v20, v20, v19
    v_xor_b32 v21, 4, v40
    ds_bpermute_b32 v21, v21, v20
    s_waitcnt lgkmcnt(0)
    v_add_f32 v20, v20, v21
    v_xor_b32 v21, 8, v40
    ds_bpermute_b32 v21, v21, v20
    s_waitcnt lgkmcnt(0)
    v_add_f32 v20, v20, v21
    v_xor_b32 v21, 16, v40
    ds_bpermute_b32 v21, v21, v20
    s_waitcnt lgkmcnt(0)
    v_add_f32 v20, v20, v21
    v_xor_b32 v21, 32, v40
    ds_bpermute_b32 v21, v21, v20
    s_waitcnt lgkmcnt(0)
    v_add_f32 v20, v20, v21
    v_xor_b32 v21, 64, v40
    ds_bpermute_b32 v21, v21, v20
    s_waitcnt lgkmcnt(0)
    v_add_f32 v20, v20, v21
    v_xor_b32 v21, 128, v40
    ds_bpermute_b32 v21, v21, v20
    s_waitcnt lgkmcnt(0)
    v_add_f32 v20, v20, v21
    v_mul_f32 v22, 0x3acccccd, v20
    v_mov_b32 v20, 0
    v_sub_f32 v21, v10, v22
    v_fmac_f32 v20, v21, v21
    v_sub_f32 v21, v11, v22
    v_fmac_f32 v20, v21, v21
    v_sub_f32 v21, v12, v22
    v_fmac_f32 v20, v21, v21
    v_sub_f32 v21, v13, v22
    v_fmac_f32 v20, v21, v21
    v_sub_f32 v21, v14, v22
    v_fmac_f32 v20, v21, v21
    v_sub_f32 v21, v15, v22
    v_fmac_f32 v20, v21, v21
    v_sub_f32 v21, v16, v22
    v_fmac_f32 v20, v21, v21
    v_sub_f32 v21, v17, v22
    v_fmac_f32 v20, v21, v21
    v_sub_f32 v21, v18, v22
    v_fmac_f32 v20, v21, v21
    v_sub_f32 v21, v19, v22
    v_fmac_f32 v20, v21, v21
    v_xor_b32 v21, 4, v40
    ds_bpermute_b32 v21, v21, v20
    s_waitcnt lgkmcnt(0)
    v_add_f32 v20, v20, v21
    v_xor_b32 v21, 8, v40
    ds_bpermute_b32 v21, v21, v20
    s_waitcnt lgkmcnt(0)
    v_add_f32 v20, v20, v21
    v_xor_b32 v21, 16, v40
    ds_bpermute_b32 v21, v21, v20
    s_waitcnt lgkmcnt(0)
    v_add_f32 v20, v20, v21
    v_xor_b32 v21, 32, v40
    ds_bpermute_b32 v21, v21, v20
    s_waitcnt lgkmcnt(0)
    v_add_f32 v20, v20, v21
    v_xor_b32 v21, 64, v40
    ds_bpermute_b32 v21, v21, v20
    s_waitcnt lgkmcnt(0)
    v_add_f32 v20, v20, v21
    v_xor_b32 v21, 128, v40
    ds_bpermute_b32 v21, v21, v20
    s_waitcnt lgkmcnt(0)
    v_add_f32 v20, v20, v21
    v_mul_f32 v20, 0x3acccccd, v20
    v_cvt_pk_bf16_f32 v22, v22, v22
    v_lshlrev_b32 v22, 16, v22
    v_cvt_pk_bf16_f32 v20, v20, v20
    v_lshlrev_b32 v20, 16, v20
    v_add_f32 v20, 0x3727c5ac, v20
    v_cvt_pk_bf16_f32 v20, v20, v20
    v_lshlrev_b32 v20, 16, v20
    v_sqrt_f32 v20, v20
    s_nop 0
    v_cvt_pk_bf16_f32 v20, v20, v20
    v_lshlrev_b32 v20, 16, v20
    v_rcp_f32 v23, v20
    s_nop 0
    v_sub_f32 v10, v10, v22
    v_cvt_pk_bf16_f32 v10, v10, v10
    v_lshlrev_b32 v10, 16, v10
    v_mul_f32 v24, v10, v23
    v_fma_f32 v25, -v24, v20, v10
    v_fma_f32 v10, v25, v23, v24
    v_sub_f32 v11, v11, v22
    v_cvt_pk_bf16_f32 v11, v11, v11
    v_lshlrev_b32 v11, 16, v11
    v_mul_f32 v24, v11, v23
    v_fma_f32 v25, -v24, v20, v11
    v_fma_f32 v11, v25, v23, v24
    v_sub_f32 v12, v12, v22
    v_cvt_pk_bf16_f32 v12, v12, v12
    v_lshlrev_b32 v12, 16, v12
    v_mul_f32 v24, v12, v23
    v_fma_f32 v25, -v24, v20, v12
    v_fma_f32 v12, v25, v23, v24
    v_sub_f32 v13, v13, v22
    v_cvt_pk_bf16_f32 v13, v13, v13
    v_lshlrev_b32 v13, 16, v13
    v_mul_f32 v24, v13, v23
    v_fma_f32 v25, -v24, v20, v13
    v_fma_f32 v13, v25, v23, v24
    v_sub_f32 v14, v14, v22
    v_cvt_pk_bf16_f32 v14, v14, v14
    v_lshlrev_b32 v14, 16, v14
    v_mul_f32 v24, v14, v23
    v_fma_f32 v25, -v24, v20, v14
    v_fma_f32 v14, v25, v23, v24
    v_sub_f32 v15, v15, v22
    v_cvt_pk_bf16_f32 v15, v15, v15
    v_lshlrev_b32 v15, 16, v15
    v_mul_f32 v24, v15, v23
    v_fma_f32 v25, -v24, v20, v15
    v_fma_f32 v15, v25, v23, v24
    v_sub_f32 v16, v16, v22
    v_cvt_pk_bf16_f32 v16, v16, v16
    v_lshlrev_b32 v16, 16, v16
    v_mul_f32 v24, v16, v23
    v_fma_f32 v25, -v24, v20, v16
    v_fma_f32 v16, v25, v23, v24
    v_sub_f32 v17, v17, v22
    v_cvt_pk_bf16_f32 v17, v17, v17
    v_lshlrev_b32 v17, 16, v17
    v_mul_f32 v24, v17, v23
    v_fma_f32 v25, -v24, v20, v17
    v_fma_f32 v17, v25, v23, v24
    v_sub_f32 v18, v18, v22
    v_cvt_pk_bf16_f32 v18, v18, v18
    v_lshlrev_b32 v18, 16, v18
    v_mul_f32 v24, v18, v23
    v_fma_f32 v25, -v24, v20, v18
    v_fma_f32 v18, v25, v23, v24
    v_sub_f32 v19, v19, v22
    v_cvt_pk_bf16_f32 v19, v19, v19
    v_lshlrev_b32 v19, 16, v19
    v_mul_f32 v24, v19, v23
    v_fma_f32 v25, -v24, v20, v19
    v_fma_f32 v19, v25, v23, v24
    v_cvt_pk_bf16_f32 v2, v10, v11
    buffer_store_dword v2, v1, s[32:35], 0 offen offset:0
    v_cvt_pk_bf16_f32 v3, v12, v13
    buffer_store_dword v3, v1, s[32:35], 0 offen offset:256
    v_cvt_pk_bf16_f32 v4, v14, v15
    buffer_store_dword v4, v1, s[32:35], 0 offen offset:512
    v_cvt_pk_bf16_f32 v5, v16, v17
    buffer_store_dword v5, v1, s[32:35], 0 offen offset:768
    v_cvt_pk_bf16_f32 v6, v18, v19
    buffer_store_dword v6, v1, s[32:35], 0 offen offset:1024
ln2_kernel_end:
    s_endpgm
.section .rodata,"a"
.p2align 6
.amdhsa_kernel ln2_kernel
  .amdhsa_next_free_vgpr 48
  .amdhsa_next_free_sgpr 100
  .amdhsa_accum_offset 48
  .amdhsa_group_segment_fixed_size 0
  .amdhsa_kernarg_size 88
  .amdhsa_user_sgpr_count 2
  .amdhsa_user_sgpr_kernarg_segment_ptr 1
  .amdhsa_system_sgpr_workgroup_id_x 1
.end_amdhsa_kernel
.text
.globl dft_kernel
.p2align 8
.type dft_kernel,@function
dft_kernel:
    s_load_dwordx4 s[4:7], s[0:1], 0
    s_load_dwordx2 s[8:9], s[0:1], 16
    s_load_dwordx4 s[12:15], s[0:1], 32
    s_load_dwordx4 s[16:19], s[0:1], 48
    s_load_dwordx2 s[20:21], s[0:1], 64
    s_load_dwordx2 s[24:25], s[0:1], 80
    s_waitcnt lgkmcnt(0)
    s_cmp_ge_u32 s2, 224
    s_cbranch_scc1 dft_kernel_end
    s_and_b32 s36, s2, 31
    s_lshr_b32 s37, s2, 5
    s_add_u32 s28, s24, 7340032
    s_addc_u32 s29, s25, 0
    s_mov_b32 s30, 2621440
    s_mov_b32 s31, 0x00020000
    s_add_u32 s32, s24, 4456448
    s_addc_u32 s33, s25, 0
    s_mov_b32 s34, 860160
    s_mov_b32 s35, 0x00020000
    v_lshrrev_b32 v1, 3, v0
    v_and_b32 v2, 7, v0
    s_mov_b32 s38, 16
    v_mul_lo_u32 v23, v2, s38
    v_lshlrev_b32 v2, 4, v2
    v_mul_u32_u24 v3, 160, v1
    v_add_u32 v3, v3, v2
    v_lshlrev_b32 v4, 5, v1
    v_add_u32 v4, 0, v4
    v_add_u32 v4, s36, v4
    s_mov_b32 s38, 1280
    v_mul_lo_u32 v4, v4, s38
    v_add_u32 v10, v4, v23
    v_lshlrev_b32 v4, 5, v1
    v_add_u32 v4, 1024, v4
    v_add_u32 v4, s36, v4
    s_mov_b32 s38, 1280
    v_mul_lo_u32 v4, v4, s38
    v_add_u32 v11, v4, v23
    s_mul_i32 s38, s37, 96
    v_add_u32 v4, 0, v1
    v_add_u32 v4, s38, v4
    s_mov_b32 s38, 1280
    v_mul_lo_u32 v4, v4, s38
    v_add_u32 v12, v4, v2
    s_mul_i32 s38, s37, 96
    v_add_u32 v4, 32, v1
    v_add_u32 v4, s38, v4
    s_mov_b32 s38, 1280
    v_mul_lo_u32 v4, v4, s38
    v_add_u32 v13, v4, v2
    s_mul_i32 s38, s37, 96
    v_add_u32 v4, 64, v1
    v_add_u32 v4, s38, v4
    s_mov_b32 s38, 1280
    v_mul_lo_u32 v4, v4, s38
    v_add_u32 v14, v4, v2
    v_and_b32 v5, 15, v0
    v_bfe_u32 v6, v0, 4, 2
    v_bfe_u32 v7, v0, 6, 1
    v_lshrrev_b32 v8, 7, v0
    v_lshlrev_b32 v9, 5, v7
    v_add_u32 v9, v9, v5
    v_mul_u32_u24 v20, 160, v9
    v_lshl_add_u32 v20, v6, 4, v20
    v_mul_u32_u24 v9, 48, v8
    v_add_u32 v9, v9, v5
    v_add_u32 v9, 64, v9
    v_mul_u32_u24 v21, 160, v9
    v_lshl_add_u32 v21, v6, 4, v21
    v_add_u32 v22, 25600, v3
    s_mov_b32 s39, 0
    s_mov_b32 s52, 0
    buffer_load_dwordx4 v[24:27], v10, s[28:31], s39 offen
    buffer_load_dwordx4 v[28:31], v11, s[28:31], s39 offen
    buffer_load_dwordx4 v[32:35], v12, s[32:35], s52 offen
    buffer_load_dwordx4 v[36:39], v13, s[32:35], s52 offen
    buffer_load_dwordx4 v[40:43], v14, s[32:35], s52 offen
    s_add_u32 s39, s39, 128
    s_add_u32 s52, s52, 128
    buffer_load_dwordx4 v[44:47], v10, s[28:31], s39 offen
    buffer_load_dwordx4 v[48:51], v11, s[28:31], s39 offen
    buffer_load_dwordx4 v[52:55], v12, s[32:35], s52 offen
    buffer_load_dwordx4 v[56:59], v13, s[32:35], s52 offen
    buffer_load_dwordx4 v[60:63], v14, s[32:35], s52 offen
    v_mov_b32 v104, 0
    v_mov_b32 v105, 0
    v_mov_b32 v106, 0
    v_mov_b32 v107, 0
    v_mov_b32 v108, 0
    v_mov_b32 v109, 0
    v_mov_b32 v110, 0
    v_mov_b32 v111, 0
    v_mov_b32 v112, 0
    v_mov_b32 v113, 0
    v_mov_b32 v114, 0
    v_mov_b32 v115, 0
    v_mov_b32 v116, 0
    v_mov_b32 v117, 0
    v_mov_b32 v118, 0
    v_mov_b32 v119, 0
    v_mov_b32 v120, 0
    v_mov_b32 v121, 0
    v_mov_b32 v122, 0
    v_mov_b32 v123, 0
    v_mov_b32 v124, 0
    v_mov_b32 v125, 0
    v_mov_b32 v126, 0
    v_mov_b32 v127, 0
    s_waitcnt vmcnt(5)
    ds_write_b128 v3, v[24:27] offset:0
    ds_write_b128 v3, v[28:31] offset:5120
    ds_write_b128 v3, v[32:35] offset:10240
    ds_write_b128 v3, v[36:39] offset:15360
    ds_write_b128 v3, v[40:43] offset:20480
    s_waitcnt lgkmcnt(0)
    s_barrier
    s_mov_b32 s53, 4
dft_kernel_loop:
    s_add_u32 s39, s39, 128
    s_add_u32 s52, s52, 128
    buffer_load_dwordx4 v[24:27], v10, s[28:31], s39 offen
    buffer_load_dwordx4 v[28:31], v11, s[28:31], s39 offen
    buffer_load_dwordx4 v[32:35], v12, s[32:35], s52 offen
    buffer_load_dwordx4 v[36:39], v13, s[32:35], s52 offen
    buffer_load_dwordx4 v[40:43], v14, s[32:35], s52 offen
    ds_read_b128 v[64:67], v20 offset:0
    ds_read_b128 v[68:71], v20 offset:2560
    ds_read_b128 v[72:75], v21 offset:0
    ds_read_b128 v[76:79], v21 offset:2560
    ds_read_b128 v[80:83], v21 offset:5120
    ds_read_b128 v[84:87], v20 offset:64
    ds_read_b128 v[88:91], v20 offset:2624
    ds_read_b128 v[92:95], v21 offset:64
    ds_read_b128 v[96:99], v21 offset:2624
    ds_read_b128 v[100:103], v21 offset:5184
    s_waitcnt vmcnt(5)
    ds_write_b128 v22, v[44:47] offset:0
    ds_write_b128 v22, v[48:51] offset:5120
    ds_write_b128 v22, v[52:55] offset:10240
    ds_write_b128 v22, v[56:59] offset:15360
    ds_write_b128 v22, v[60:63] offset:20480
    s_waitcnt lgkmcnt(10)
    v_mfma_f32_16x16x32_bf16 v[104:107], v[64:67], v[72:75], v[104:107]
    v_mfma_f32_16x16x32_bf16 v[108:111], v[64:67], v[76:79], v[108:111]
    v_mfma_f32_16x16x32_bf16 v[112:115], v[64:67], v[80:83], v[112:115]
    v_mfma_f32_16x16x32_bf16 v[116:119], v[68:71], v[72:75], v[116:119]
    v_mfma_f32_16x16x32_bf16 v[120:123], v[68:71], v[76:79], v[120:123]
    v_mfma_f32_16x16x32_bf16 v[124:127], v[68:71], v[80:83], v[124:127]
    s_waitcnt lgkmcnt(5)
    v_mfma_f32_16x16x32_bf16 v[104:107], v[84:87], v[92:95], v[104:107]
    v_mfma_f32_16x16x32_bf16 v[108:111], v[84:87], v[96:99], v[108:111]
    v_mfma_f32_16x16x32_bf16 v[112:115], v[84:87], v[100:103], v[112:115]
    v_mfma_f32_16x16x32_bf16 v[116:119], v[88:91], v[92:95], v[116:119]
    v_mfma_f32_16x16x32_bf16 v[120:123], v[88:91], v[96:99], v[120:123]
    v_mfma_f32_16x16x32_bf16 v[124:127], v[88:91], v[100:103], v[124:127]
    s_waitcnt lgkmcnt(0)
    s_barrier
    s_add_u32 s39, s39, 128
    s_add_u32 s52, s52, 128
    buffer_load_dwordx4 v[44:47], v10, s[28:31], s39 offen
    buffer_load_dwordx4 v[48:51], v11, s[28:31], s39 offen
    buffer_load_dwordx4 v[52:55], v12, s[32:35], s52 offen
    buffer_load_dwordx4 v[56:59], v13, s[32:35], s52 offen
    buffer_load_dwordx4 v[60:63], v14, s[32:35], s52 offen
    ds_read_b128 v[64:67], v20 offset:25600
    ds_read_b128 v[68:71], v20 offset:28160
    ds_read_b128 v[72:75], v21 offset:25600
    ds_read_b128 v[76:79], v21 offset:28160
    ds_read_b128 v[80:83], v21 offset:30720
    ds_read_b128 v[84:87], v20 offset:25664
    ds_read_b128 v[88:91], v20 offset:28224
    ds_read_b128 v[92:95], v21 offset:25664
    ds_read_b128 v[96:99], v21 offset:28224
    ds_read_b128 v[100:103], v21 offset:30784
    s_waitcnt vmcnt(5)
    ds_write_b128 v3, v[24:27] offset:0
    ds_write_b128 v3, v[28:31] offset:5120
    ds_write_b128 v3, v[32:35] offset:10240
    ds_write_b128 v3, v[36:39] offset:15360
    ds_write_b128 v3, v[40:43] offset:20480
    s_waitcnt lgkmcnt(10)
    v_mfma_f32_16x16x32_bf16 v[104:107], v[64:67], v[72:75], v[104:107]
    v_mfma_f32_16x16x32_bf16 v[108:111], v[64:67], v[76:79], v[108:111]
    v_mfma_f32_16x16x32_bf16 v[112:115], v[64:67], v[80:83], v[112:115]
    v_mfma_f32_16x16x32_bf16 v[116:119], v[68:71], v[72:75], v[116:119]
    v_mfma_f32_16x16x32_bf16 v[120:123], v[68:71], v[76:79], v[120:123]
    v_mfma_f32_16x16x32_bf16 v[124:127], v[68:71], v[80:83], v[124:127]
    s_waitcnt lgkmcnt(5)
    v_mfma_f32_16x16x32_bf16 v[104:107], v[84:87], v[92:95], v[104:107]
    v_mfma_f32_16x16x32_bf16 v[108:111], v[84:87], v[96:99], v[108:111]
    v_mfma_f32_16x16x32_bf16 v[112:115], v[84:87], v[100:103], v[112:115]
    v_mfma_f32_16x16x32_bf16 v[116:119], v[88:91], v[92:95], v[116:119]
    v_mfma_f32_16x16x32_bf16 v[120:123], v[88:91], v[96:99], v[120:123]
    v_mfma_f32_16x16x32_bf16 v[124:127], v[88:91], v[100:103], v[124:127]
    s_waitcnt lgkmcnt(0)
    s_barrier
    s_sub_u32 s53, s53, 1
    s_cmp_lg_u32 s53, 0
    s_cbranch_scc1 dft_kernel_loop
    ds_read_b128 v[64:67], v20 offset:0
    ds_read_b128 v[68:71], v20 offset:2560
    ds_read_b128 v[72:75], v21 offset:0
    ds_read_b128 v[76:79], v21 offset:2560
    ds_read_b128 v[80:83], v21 offset:5120
    ds_read_b128 v[84:87], v20 offset:64
    ds_read_b128 v[88:91], v20 offset:2624
    ds_read_b128 v[92:95], v21 offset:64
    ds_read_b128 v[96:99], v21 offset:2624
    ds_read_b128 v[100:103], v21 offset:5184
    s_waitcnt vmcnt(0)
    ds_write_b128 v22, v[44:47] offset:0
    ds_write_b128 v22, v[48:51] offset:5120
    ds_write_b128 v22, v[52:55] offset:10240
    ds_write_b128 v22, v[56:59] offset:15360
    ds_write_b128 v22, v[60:63] offset:20480
    s_waitcnt lgkmcnt(10)
    v_mfma_f32_16x16x32_bf16 v[104:107], v[64:67], v[72:75], v[104:107]
    v_mfma_f32_16x16x32_bf16 v[108:111], v[64:67], v[76:79], v[108:111]
    v_mfma_f32_16x16x32_bf16 v[112:115], v[64:67], v[80:83], v[112:115]
    v_mfma_f32_16x16x32_bf16 v[116:119], v[68:71], v[72:75], v[116:119]
    v_mfma_f32_16x16x32_bf16 v[120:123], v[68:71], v[76:79], v[120:123]
    v_mfma_f32_16x16x32_bf16 v[124:127], v[68:71], v[80:83], v[124:127]
    s_waitcnt lgkmcnt(5)
    v_mfma_f32_16x16x32_bf16 v[104:107], v[84:87], v[92:95], v[104:107]
    v_mfma_f32_16x16x32_bf16 v[108:111], v[84:87], v[96:99], v[108:111]
    v_mfma_f32_16x16x32_bf16 v[112:115], v[84:87], v[100:103], v[112:115]
    v_mfma_f32_16x16x32_bf16 v[116:119], v[88:91], v[92:95], v[116:119]
    v_mfma_f32_16x16x32_bf16 v[120:123], v[88:91], v[96:99], v[120:123]
    v_mfma_f32_16x16x32_bf16 v[124:127], v[88:91], v[100:103], v[124:127]
    s_waitcnt lgkmcnt(0)
    s_barrier
    ds_read_b128 v[64:67], v20 offset:25600
    ds_read_b128 v[68:71], v20 offset:28160
    ds_read_b128 v[72:75], v21 offset:25600
    ds_read_b128 v[76:79], v21 offset:28160
    ds_read_b128 v[80:83], v21 offset:30720
    ds_read_b128 v[84:87], v20 offset:25664
    ds_read_b128 v[88:91], v20 offset:28224
    ds_read_b128 v[92:95], v21 offset:25664
    ds_read_b128 v[96:99], v21 offset:28224
    ds_read_b128 v[100:103], v21 offset:30784
    s_waitcnt lgkmcnt(5)
    v_mfma_f32_16x16x32_bf16 v[104:107], v[64:67], v[72:75], v[104:107]
    v_mfma_f32_16x16x32_bf16 v[108:111], v[64:67], v[76:79], v[108:111]
    v_mfma_f32_16x16x32_bf16 v[112:115], v[64:67], v[80:83], v[112:115]
    v_mfma_f32_16x16x32_bf16 v[116:119], v[68:71], v[72:75], v[116:119]
    v_mfma_f32_16x16x32_bf16 v[120:123], v[68:71], v[76:79], v[120:123]
    v_mfma_f32_16x16x32_bf16 v[124:127], v[68:71], v[80:83], v[124:127]
    s_waitcnt lgkmcnt(0)
    v_mfma_f32_16x16x32_bf16 v[104:107], v[84:87], v[92:95], v[104:107]
    v_mfma_f32_16x16x32_bf16 v[108:111], v[84:87], v[96:99], v[108:111]
    v_mfma_f32_16x16x32_bf16 v[112:115], v[84:87], v[100:103], v[112:115]
    v_mfma_f32_16x16x32_bf16 v[116:119], v[88:91], v[92:95], v[116:119]
    v_mfma_f32_16x16x32_bf16 v[120:123], v[88:91], v[96:99], v[120:123]
    v_mfma_f32_16x16x32_bf16 v[124:127], v[88:91], v[100:103], v[124:127]
    s_nop 15
    s_mul_i32 s38, s37, 96
    v_mul_u32_u24 v9, 48, v8
    v_add_u32 v9, s38, v9
    v_lshlrev_b32 v1, 5, v7
    s_add_u32 s40, s24, 10485760
    s_addc_u32 s41, s25, 0
    s_mov_b32 s42, 8388608
    s_mov_b32 s43, 0x00020000
    v_add_u32 v9, v9, v5
    v_lshl_add_u32 v1, v6, 2, v1
    v_lshlrev_b32 v2, 11, v9
    s_lshl_b32 s38, s36, 6
    v_add_u32 v2, s38, v2
    v_add_u32 v2, v2, v1
    v_lshlrev_b32 v2, 1, v2
    v_cvt_pk_bf16_f32 v24, v104, v105
    v_cvt_pk_bf16_f32 v25, v106, v107
    v_add_u32 v12, 0, v2
    buffer_store_dwordx2 v[24:25], v12, s[40:43], 0 offen
    v_cvt_pk_bf16_f32 v26, v108, v109
    v_cvt_pk_bf16_f32 v27, v110, v111
    v_add_u32 v12, 65536, v2
    buffer_store_dwordx2 v[26:27], v12, s[40:43], 0 offen
    v_cvt_pk_bf16_f32 v28, v112, v113
    v_cvt_pk_bf16_f32 v29, v114, v115
    v_add_u32 v12, 131072, v2
    buffer_store_dwordx2 v[28:29], v12, s[40:43], 0 offen
    v_cvt_pk_bf16_f32 v30, v116, v117
    v_cvt_pk_bf16_f32 v31, v118, v119
    v_add_u32 v12, 32, v2
    buffer_store_dwordx2 v[30:31], v12, s[40:43], 0 offen
    v_cvt_pk_bf16_f32 v32, v120, v121
    v_cvt_pk_bf16_f32 v33, v122, v123
    v_add_u32 v12, 65568, v2
    buffer_store_dwordx2 v[32:33], v12, s[40:43], 0 offen
    v_cvt_pk_bf16_f32 v34, v124, v125
    v_cvt_pk_bf16_f32 v35, v126, v127
    v_add_u32 v12, 131104, v2
    buffer_store_dwordx2 v[34:35], v12, s[40:43], 0 offen
dft_kernel_end:
    s_endpgm
.section .rodata,"a"
.p2align 6
.amdhsa_kernel dft_kernel
  .amdhsa_next_free_vgpr 128
  .amdhsa_next_free_sgpr 100
  .amdhsa_accum_offset 128
  .amdhsa_group_segment_fixed_size 0
  .amdhsa_kernarg_size 88
  .amdhsa_user_sgpr_count 2
  .amdhsa_user_sgpr_kernarg_segment_ptr 1
  .amdhsa_system_sgpr_workgroup_id_x 1
.end_amdhsa_kernel
.text
.globl col_kernel
.p2align 8
.type col_kernel,@function
col_kernel:
    s_load_dwordx4 s[4:7], s[0:1], 0
    s_load_dwordx2 s[8:9], s[0:1], 16
    s_load_dwordx4 s[12:15], s[0:1], 32
    s_load_dwordx4 s[16:19], s[0:1], 48
    s_load_dwordx2 s[20:21], s[0:1], 64
    s_load_dwordx2 s[24:25], s[0:1], 80
    s_waitcnt lgkmcnt(0)
    s_cmp_ge_u32 s2, 84
    s_cbranch_scc1 col_end
    s_add_u32 s28, s24, 10485760
    s_addc_u32 s29, s25, 0
    s_mov_b32 s30, 2752512
    s_mov_b32 s31, 0x00020000
    s_add_u32 s32, s24, 6291456
    s_addc_u32 s33, s25, 0
    s_mov_b32 s34, 20480
    s_mov_b32 s35, 0x00020000
    s_add_u32 s36, s24, 31457280
    s_addc_u32 s37, s25, 0
    s_mov_b32 s38, 2752512
    s_mov_b32 s39, 0x00020000
    s_add_u32 s44, s24, 13631488
    s_addc_u32 s45, s25, 0
    s_mov_b32 s46, 2752512
    s_mov_b32 s47, 0x00020000
    v_and_b32 v1, 15, v0
    v_bfe_u32 v2, v0, 4, 2
    v_lshrrev_b32 v3, 7, v0
    v_bfe_u32 v41, v0, 6, 1
    s_lshl_b32 s3, s2, 2
    v_add_u32 v4, s3, v3
    v_lshlrev_b32 v5, 13, v4
    v_lshl_add_u32 v5, v1, 7, v5
    v_lshl_add_u32 v5, v2, 4, v5
    v_lshl_add_u32 v5, v41, 11, v5
    v_add_u32 v6, 4096, v5
    buffer_load_dwordx4 v[16:19], v5, s[28:31], 0 offen offset:0
    buffer_load_dwordx4 v[20:23], v5, s[28:31], 0 offen offset:64
    buffer_load_dwordx4 v[32:35], v6, s[28:31], 0 offen offset:0
    buffer_load_dwordx4 v[36:39], v6, s[28:31], 0 offen offset:64
    v_lshlrev_b32 v7, 7, v1
    v_lshl_add_u32 v7, v2, 4, v7
    v_add_u32 v6, 4096, v7
    buffer_load_dwordx4 v[64:67], v7, s[32:35], 0 offen offset:0
    buffer_load_dwordx4 v[68:71], v7, s[32:35], 0 offen offset:64
    buffer_load_dwordx4 v[72:75], v7, s[32:35], 0 offen offset:2048
    buffer_load_dwordx4 v[76:79], v7, s[32:35], 0 offen offset:2112
    buffer_load_dwordx4 v[80:83], v6, s[32:35], 0 offen offset:0
    buffer_load_dwordx4 v[84:87], v6, s[32:35], 0 offen offset:64
    buffer_load_dwordx4 v[88:91], v6, s[32:35], 0 offen offset:2048
    buffer_load_dwordx4 v[92:95], v6, s[32:35], 0 offen offset:2112
    v_add_u32 v7, 8192, v7
    v_add_u32 v6, 4096, v7
    buffer_load_dwordx4 v[96:99], v7, s[32:35], 0 offen offset:0
    buffer_load_dwordx4 v[100:103], v7, s[32:35], 0 offen offset:64
    buffer_load_dwordx4 v[104:107], v7, s[32:35], 0 offen offset:2048
    buffer_load_dwordx4 v[108:111], v7, s[32:35], 0 offen offset:2112
    buffer_load_dwordx4 v[112:115], v6, s[32:35], 0 offen offset:0
    buffer_load_dwordx4 v[116:119], v6, s[32:35], 0 offen offset:64
    buffer_load_dwordx4 v[120:123], v6, s[32:35], 0 offen offset:2048
    buffer_load_dwordx4 v[124:127], v6, s[32:35], 0 offen offset:2112
    v_add_u32 v7, 8192, v7
    v_lshlrev_b32 v8, 13, v4
    v_and_b32 v9, 63, v0
    v_lshl_add_u32 v8, v9, 4, v8
    v_lshl_add_u32 v8, v41, 11, v8
    v_add_u32 v9, 4096, v8
    buffer_load_dwordx4 v[192:195], v8, s[36:39], 0 offen offset:0
    buffer_load_dwordx4 v[196:199], v8, s[36:39], 0 offen offset:1024
    buffer_load_dwordx4 v[200:203], v9, s[36:39], 0 offen offset:0
    buffer_load_dwordx4 v[204:207], v9, s[36:39], 0 offen offset:1024
    s_waitcnt vmcnt(4)
    v_xor_b32 v48, 0x80008000, v16
    v_xor_b32 v49, 0x80008000, v17
    v_xor_b32 v50, 0x80008000, v18
    v_xor_b32 v51, 0x80008000, v19
    v_xor_b32 v52, 0x80008000, v20
    v_xor_b32 v53, 0x80008000, v21
    v_xor_b32 v54, 0x80008000, v22
    v_xor_b32 v55, 0x80008000, v23
    s_nop 1
    v_mfma_f32_16x16x32_bf16 v[128:131], v[16:19], v[64:67], 0
    v_mfma_f32_16x16x32_bf16 v[128:131], v[32:35], v[96:99], v[128:131]
    v_mfma_f32_16x16x32_bf16 v[160:163], v[32:35], v[64:67], 0
    v_mfma_f32_16x16x32_bf16 v[160:163], v[48:51], v[96:99], v[160:163]
    v_mfma_f32_16x16x32_bf16 v[128:131], v[20:23], v[68:71], v[128:131]
    v_mfma_f32_16x16x32_bf16 v[128:131], v[36:39], v[100:103], v[128:131]
    v_mfma_f32_16x16x32_bf16 v[160:163], v[36:39], v[68:71], v[160:163]
    v_mfma_f32_16x16x32_bf16 v[160:163], v[52:55], v[100:103], v[160:163]
    v_mfma_f32_16x16x32_bf16 v[132:135], v[16:19], v[72:75], 0
    v_mfma_f32_16x16x32_bf16 v[132:135], v[32:35], v[104:107], v[132:135]
    v_mfma_f32_16x16x32_bf16 v[164:167], v[32:35], v[72:75], 0
    v_mfma_f32_16x16x32_bf16 v[164:167], v[48:51], v[104:107], v[164:167]
    v_mfma_f32_16x16x32_bf16 v[132:135], v[20:23], v[76:79], v[132:135]
    v_mfma_f32_16x16x32_bf16 v[132:135], v[36:39], v[108:111], v[132:135]
    v_mfma_f32_16x16x32_bf16 v[164:167], v[36:39], v[76:79], v[164:167]
    v_mfma_f32_16x16x32_bf16 v[164:167], v[52:55], v[108:111], v[164:167]
    v_mfma_f32_16x16x32_bf16 v[136:139], v[16:19], v[80:83], 0
    v_mfma_f32_16x16x32_bf16 v[136:139], v[32:35], v[112:115], v[136:139]
    v_mfma_f32_16x16x32_bf16 v[168:171], v[32:35], v[80:83], 0
    v_mfma_f32_16x16x32_bf16 v[168:171], v[48:51], v[112:115], v[168:171]
    v_mfma_f32_16x16x32_bf16 v[136:139], v[20:23], v[84:87], v[136:139]
    v_mfma_f32_16x16x32_bf16 v[136:139], v[36:39], v[116:119], v[136:139]
    v_mfma_f32_16x16x32_bf16 v[168:171], v[36:39], v[84:87], v[168:171]
    v_mfma_f32_16x16x32_bf16 v[168:171], v[52:55], v[116:119], v[168:171]
    v_mfma_f32_16x16x32_bf16 v[140:143], v[16:19], v[88:91], 0
    v_mfma_f32_16x16x32_bf16 v[140:143], v[32:35], v[120:123], v[140:143]
    v_mfma_f32_16x16x32_bf16 v[172:175], v[32:35], v[88:91], 0
    v_mfma_f32_16x16x32_bf16 v[172:175], v[48:51], v[120:123], v[172:175]
    v_mfma_f32_16x16x32_bf16 v[140:143], v[20:23], v[92:95], v[140:143]
    v_mfma_f32_16x16x32_bf16 v[140:143], v[36:39], v[124:127], v[140:143]
    v_mfma_f32_16x16x32_bf16 v[172:175], v[36:39], v[92:95], v[172:175]
    v_mfma_f32_16x16x32_bf16 v[172:175], v[52:55], v[124:127], v[172:175]
    s_nop 7
    v_mul_u32_u24 v10, 9216, v3
    v_mul_u32_u24 v47, 144, v1
    v_lshlrev_b32 v9, 2, v2
    v_lshl_add_u32 v42, v41, 4, v9
    v_lshl_add_u32 v43, v41, 5, v9
    v_add_u32 v5, v47, v10
    v_lshl_add_u32 v5, v2, 3, v5
    v_lshl_add_u32 v5, v41, 5, v5
    v_add_u32 v11, 0, v42
    v_add_u32 v12, 0, v1
    v_mul_u32_u24 v11, v11, v12
    v_cvt_f32_u32 v11, v11
    v_mul_f32 v11, 0x3a000000, v11
    v_cos_f32 v12, v11
    v_sin_f32 v13, v11
    s_nop 0
    v_mul_f32 v14, v160, v13
    v_mul_f32 v15, v128, v13
    v_fma_f32 v128, v128, v12, v14
    v_fma_f32 v160, v160, v12, -v15
    v_add_u32 v11, 1, v42
    v_add_u32 v12, 0, v1
    v_mul_u32_u24 v11, v11, v12
    v_cvt_f32_u32 v11, v11
    v_mul_f32 v11, 0x3a000000, v11
    v_cos_f32 v12, v11
    v_sin_f32 v13, v11
    s_nop 0
    v_mul_f32 v14, v161, v13
    v_mul_f32 v15, v129, v13
    v_fma_f32 v129, v129, v12, v14
    v_fma_f32 v161, v161, v12, -v15
    v_add_u32 v11, 2, v42
    v_add_u32 v12, 0, v1
    v_mul_u32_u24 v11, v11, v12
    v_cvt_f32_u32 v11, v11
    v_mul_f32 v11, 0x3a000000, v11
    v_cos_f32 v12, v11
    v_sin_f32 v13, v11
    s_nop 0
    v_mul_f32 v14, v162, v13
    v_mul_f32 v15, v130, v13
    v_fma_f32 v130, v130, v12, v14
    v_fma_f32 v162, v162, v12, -v15
    v_add_u32 v11, 3, v42
    v_add_u32 v12, 0, v1
    v_mul_u32_u24 v11, v11, v12
    v_cvt_f32_u32 v11, v11
    v_mul_f32 v11, 0x3a000000, v11
    v_cos_f32 v12, v11
    v_sin_f32 v13, v11
    s_nop 0
    v_mul_f32 v14, v163, v13
    v_mul_f32 v15, v131, v13
    v_fma_f32 v131, v131, v12, v14
    v_fma_f32 v163, v163, v12, -v15
    v_cvt_pk_bf16_f32 v14, v128, v129
    v_cvt_pk_bf16_f32 v15, v130, v131
    ds_write_b64 v5, v[14:15] offset:0
    v_cvt_pk_bf16_f32 v14, v160, v161
    v_cvt_pk_bf16_f32 v15, v162, v163
    ds_write_b64 v5, v[14:15] offset:64
    v_add_u32 v11, 0, v42
    v_add_u32 v12, 16, v1
    v_mul_u32_u24 v11, v11, v12
    v_cvt_f32_u32 v11, v11
    v_mul_f32 v11, 0x3a000000, v11
    v_cos_f32 v12, v11
    v_sin_f32 v13, v11
    s_nop 0
    v_mul_f32 v14, v164, v13
    v_mul_f32 v15, v132, v13
    v_fma_f32 v132, v132, v12, v14
    v_fma_f32 v164, v164, v12, -v15
    v_add_u32 v11, 1, v42
    v_add_u32 v12, 16, v1
    v_mul_u32_u24 v11, v11, v12
    v_cvt_f32_u32 v11, v11
    v_mul_f32 v11, 0x3a000000, v11
    v_cos_f32 v12, v11
    v_sin_f32 v13, v11
    s_nop 0
    v_mul_f32 v14, v165, v13
    v_mul_f32 v15, v133, v13
    v_fma_f32 v133, v133, v12, v14
    v_fma_f32 v165, v165, v12, -v15
    v_add_u32 v11, 2, v42
    v_add_u32 v12, 16, v1
    v_mul_u32_u24 v11, v11, v12
    v_cvt_f32_u32 v11, v11
    v_mul_f32 v11, 0x3a000000, v11
    v_cos_f32 v12, v11
    v_sin_f32 v13, v11
    s_nop 0
    v_mul_f32 v14, v166, v13
    v_mul_f32 v15, v134, v13
    v_fma_f32 v134, v134, v12, v14
    v_fma_f32 v166, v166, v12, -v15
    v_add_u32 v11, 3, v42
    v_add_u32 v12, 16, v1
    v_mul_u32_u24 v11, v11, v12
    v_cvt_f32_u32 v11, v11
    v_mul_f32 v11, 0x3a000000, v11
    v_cos_f32 v12, v11
    v_sin_f32 v13, v11
    s_nop 0
    v_mul_f32 v14, v167, v13
    v_mul_f32 v15, v135, v13
    v_fma_f32 v135, v135, v12, v14
    v_fma_f32 v167, v167, v12, -v15
    v_cvt_pk_bf16_f32 v14, v132, v133
    v_cvt_pk_bf16_f32 v15, v134, v135
    ds_write_b64 v5, v[14:15] offset:2304
    v_cvt_pk_bf16_f32 v14, v164, v165
    v_cvt_pk_bf16_f32 v15, v166, v167
    ds_write_b64 v5, v[14:15] offset:2368
    v_add_u32 v11, 0, v42
    v_add_u32 v12, 32, v1
    v_mul_u32_u24 v11, v11, v12
    v_cvt_f32_u32 v11, v11
    v_mul_f32 v11, 0x3a000000, v11
    v_cos_f32 v12, v11
    v_sin_f32 v13, v11
    s_nop 0
    v_mul_f32 v14, v168, v13
    v_mul_f32 v15, v136, v13
    v_fma_f32 v136, v136, v12, v14
    v_fma_f32 v168, v168, v12, -v15
    v_add_u32 v11, 1, v42
    v_add_u32 v12, 32, v1
    v_mul_u32_u24 v11, v11, v12
    v_cvt_f32_u32 v11, v11
    v_mul_f32 v11, 0x3a000000, v11
    v_cos_f32 v12, v11
    v_sin_f32 v13, v11
    s_nop 0
    v_mul_f32 v14, v169, v13
    v_mul_f32 v15, v137, v13
    v_fma_f32 v137, v137, v12, v14
    v_fma_f32 v169, v169, v12, -v15
    v_add_u32 v11, 2, v42
    v_add_u32 v12, 32, v1
    v_mul_u32_u24 v11, v11, v12
    v_cvt_f32_u32 v11, v11
    v_mul_f32 v11, 0x3a000000, v11
    v_cos_f32 v12, v11
    v_sin_f32 v13, v11
    s_nop 0
    v_mul_f32 v14, v170, v13
    v_mul_f32 v15, v138, v13
    v_fma_f32 v138, v138, v12, v14
    v_fma_f32 v170, v170, v12, -v15
    v_add_u32 v11, 3, v42
    v_add_u32 v12, 32, v1
    v_mul_u32_u24 v11, v11, v12
    v_cvt_f32_u32 v11, v11
    v_mul_f32 v11, 0x3a000000, v11
    v_cos_f32 v12, v11
    v_sin_f32 v13, v11
    s_nop 0
    v_mul_f32 v14, v171, v13
    v_mul_f32 v15, v139, v13
    v_fma_f32 v139, v139, v12, v14
    v_fma_f32 v171, v171, v12, -v15
    v_cvt_pk_bf16_f32 v14, v136, v137
    v_cvt_pk_bf16_f32 v15, v138, v139
    ds_write_b64 v5, v[14:15] offset:4608
    v_cvt_pk_bf16_f32 v14, v168, v169
    v_cvt_pk_bf16_f32 v15, v170, v171
    ds_write_b64 v5, v[14:15] offset:4672
    v_add_u32 v11, 0, v42
    v_add_u32 v12, 48, v1
    v_mul_u32_u24 v11, v11, v12
    v_cvt_f32_u32 v11, v11
    v_mul_f32 v11, 0x3a000000, v11
    v_cos_f32 v12, v11
    v_sin_f32 v13, v11
    s_nop 0
    v_mul_f32 v14, v172, v13
    v_mul_f32 v15, v140, v13
    v_fma_f32 v140, v140, v12, v14
    v_fma_f32 v172, v172, v12, -v15
    v_add_u32 v11, 1, v42
    v_add_u32 v12, 48, v1
    v_mul_u32_u24 v11, v11, v12
    v_cvt_f32_u32 v11, v11
    v_mul_f32 v11, 0x3a000000, v11
    v_cos_f32 v12, v11
    v_sin_f32 v13, v11
    s_nop 0
    v_mul_f32 v14, v173, v13
    v_mul_f32 v15, v141, v13
    v_fma_f32 v141, v141, v12, v14
    v_fma_f32 v173, v173, v12, -v15
    v_add_u32 v11, 2, v42
    v_add_u32 v12, 48, v1
    v_mul_u32_u24 v11, v11, v12
    v_cvt_f32_u32 v11, v11
    v_mul_f32 v11, 0x3a000000, v11
    v_cos_f32 v12, v11
    v_sin_f32 v13, v11
    s_nop 0
    v_mul_f32 v14, v174, v13
    v_mul_f32 v15, v142, v13
    v_fma_f32 v142, v142, v12, v14
    v_fma_f32 v174, v174, v12, -v15
    v_add_u32 v11, 3, v42
    v_add_u32 v12, 48, v1
    v_mul_u32_u24 v11, v11, v12
    v_cvt_f32_u32 v11, v11
    v_mul_f32 v11, 0x3a000000, v11
    v_cos_f32 v12, v11
    v_sin_f32 v13, v11
    s_nop 0
    v_mul_f32 v14, v175, v13
    v_mul_f32 v15, v143, v13
    v_fma_f32 v143, v143, v12, v14
    v_fma_f32 v175, v175, v12, -v15
    v_cvt_pk_bf16_f32 v14, v140, v141
    v_cvt_pk_bf16_f32 v15, v142, v143
    ds_write_b64 v5, v[14:15] offset:6912
    v_cvt_pk_bf16_f32 v14, v172, v173
    v_cvt_pk_bf16_f32 v15, v174, v175
    ds_write_b64 v5, v[14:15] offset:6976
    v_lshlrev_b32 v7, 6, v1
    v_lshl_add_u32 v7, v2, 4, v7
    v_add_u32 v6, 16384, v7
    buffer_load_dwordx4 v[208:211], v6, s[32:35], 0 offen
    v_add_u32 v6, 17408, v7
    buffer_load_dwordx4 v[212:215], v6, s[32:35], 0 offen
    v_add_u32 v6, 18432, v7
    buffer_load_dwordx4 v[216:219], v6, s[32:35], 0 offen
    v_add_u32 v6, 19456, v7
    buffer_load_dwordx4 v[220:223], v6, s[32:35], 0 offen
    s_waitcnt lgkmcnt(0)
    s_barrier
    v_add_u32 v44, v47, v10
    v_mul_u32_u24 v45, 4608, v41
    v_add_u32 v44, v44, v45
    v_lshl_add_u32 v45, v2, 3, v44
    v_lshl_add_u32 v44, v2, 4, v44
    ds_read_b128 v[16:19], v44 offset:0
    ds_read_b128 v[20:23], v44 offset:2304
    ds_read_b128 v[32:35], v44 offset:64
    ds_read_b128 v[36:39], v44 offset:2368
    s_waitcnt vmcnt(0) lgkmcnt(0)
    s_barrier
    v_xor_b32 v48, 0x80008000, v16
    v_xor_b32 v49, 0x80008000, v17
    v_xor_b32 v50, 0x80008000, v18
    v_xor_b32 v51, 0x80008000, v19
    v_xor_b32 v52, 0x80008000, v20
    v_xor_b32 v53, 0x80008000, v21
    v_xor_b32 v54, 0x80008000, v22
    v_xor_b32 v55, 0x80008000, v23
    s_nop 1
    v_mfma_f32_16x16x32_bf16 v[128:131], v[208:211], v[16:19], 0
    v_mfma_f32_16x16x32_bf16 v[128:131], v[216:219], v[32:35], v[128:131]
    v_mfma_f32_16x16x32_bf16 v[160:163], v[208:211], v[32:35], 0
    v_mfma_f32_16x16x32_bf16 v[160:163], v[216:219], v[48:51], v[160:163]
    v_mfma_f32_16x16x32_bf16 v[132:135], v[208:211], v[20:23], 0
    v_mfma_f32_16x16x32_bf16 v[132:135], v[216:219], v[36:39], v[132:135]
    v_mfma_f32_16x16x32_bf16 v[164:167], v[208:211], v[36:39], 0
    v_mfma_f32_16x16x32_bf16 v[164:167], v[216:219], v[52:55], v[164:167]
    v_mfma_f32_16x16x32_bf16 v[136:139], v[212:215], v[16:19], 0
    v_mfma_f32_16x16x32_bf16 v[136:139], v[220:223], v[32:35], v[136:139]
    v_mfma_f32_16x16x32_bf16 v[168:171], v[212:215], v[32:35], 0
    v_mfma_f32_16x16x32_bf16 v[168:171], v[220:223], v[48:51], v[168:171]
    v_mfma_f32_16x16x32_bf16 v[140:143], v[212:215], v[20:23], 0
    v_mfma_f32_16x16x32_bf16 v[140:143], v[220:223], v[36:39], v[140:143]
    v_mfma_f32_16x16x32_bf16 v[172:175], v[212:215], v[36:39], 0
    v_mfma_f32_16x16x32_bf16 v[172:175], v[220:223], v[52:55], v[172:175]
    s_nop 7
    v_lshlrev_b32 v11, 16, v192
    v_lshlrev_b32 v12, 16, v194
    v_mul_f32 v13, v160, v12
    v_mul_f32 v14, v128, v12
    v_fma_f32 v128, v128, v11, -v13
    v_fma_f32 v160, v160, v11, v14
    v_and_b32 v11, 0xffff0000, v192
    v_and_b32 v12, 0xffff0000, v194
    v_mul_f32 v13, v161, v12
    v_mul_f32 v14, v129, v12
    v_fma_f32 v129, v129, v11, -v13
    v_fma_f32 v161, v161, v11, v14
    v_lshlrev_b32 v11, 16, v193
    v_lshlrev_b32 v12, 16, v195
    v_mul_f32 v13, v162, v12
    v_mul_f32 v14, v130, v12
    v_fma_f32 v130, v130, v11, -v13
    v_fma_f32 v162, v162, v11, v14
    v_and_b32 v11, 0xffff0000, v193
    v_and_b32 v12, 0xffff0000, v195
    v_mul_f32 v13, v163, v12
    v_mul_f32 v14, v131, v12
    v_fma_f32 v131, v131, v11, -v13
    v_fma_f32 v163, v163, v11, v14
    v_cvt_pk_bf16_f32 v14, v128, v129
    v_cvt_pk_bf16_f32 v15, v130, v131
    ds_write_b64 v45, v[14:15] offset:0
    v_cvt_pk_bf16_f32 v14, v160, v161
    v_cvt_pk_bf16_f32 v15, v162, v163
    ds_write_b64 v45, v[14:15] offset:64
    v_lshlrev_b32 v11, 16, v196
    v_lshlrev_b32 v12, 16, v198
    v_mul_f32 v13, v164, v12
    v_mul_f32 v14, v132, v12
    v_fma_f32 v132, v132, v11, -v13
    v_fma_f32 v164, v164, v11, v14
    v_and_b32 v11, 0xffff0000, v196
    v_and_b32 v12, 0xffff0000, v198
    v_mul_f32 v13, v165, v12
    v_mul_f32 v14, v133, v12
    v_fma_f32 v133, v133, v11, -v13
    v_fma_f32 v165, v165, v11, v14
    v_lshlrev_b32 v11, 16, v197
    v_lshlrev_b32 v12, 16, v199
    v_mul_f32 v13, v166, v12
    v_mul_f32 v14, v134, v12
    v_fma_f32 v134, v134, v11, -v13
    v_fma_f32 v166, v166, v11, v14
    v_and_b32 v11, 0xffff0000, v197
    v_and_b32 v12, 0xffff0000, v199
    v_mul_f32 v13, v167, v12
    v_mul_f32 v14, v135, v12
    v_fma_f32 v135, v135, v11, -v13
    v_fma_f32 v167, v167, v11, v14
    v_cvt_pk_bf16_f32 v14, v132, v133
    v_cvt_pk_bf16_f32 v15, v134, v135
    ds_write_b64 v45, v[14:15] offset:2304
    v_cvt_pk_bf16_f32 v14, v164, v165
    v_cvt_pk_bf16_f32 v15, v166, v167
    ds_write_b64 v45, v[14:15] offset:2368
    v_lshlrev_b32 v11, 16, v200
    v_lshlrev_b32 v12, 16, v202
    v_mul_f32 v13, v168, v12
    v_mul_f32 v14, v136, v12
    v_fma_f32 v136, v136, v11, -v13
    v_fma_f32 v168, v168, v11, v14
    v_and_b32 v11, 0xffff0000, v200
    v_and_b32 v12, 0xffff0000, v202
    v_mul_f32 v13, v169, v12
    v_mul_f32 v14, v137, v12
    v_fma_f32 v137, v137, v11, -v13
    v_fma_f32 v169, v169, v11, v14
    v_lshlrev_b32 v11, 16, v201
    v_lshlrev_b32 v12, 16, v203
    v_mul_f32 v13, v170, v12
    v_mul_f32 v14, v138, v12
    v_fma_f32 v138, v138, v11, -v13
    v_fma_f32 v170, v170, v11, v14
    v_and_b32 v11, 0xffff0000, v201
    v_and_b32 v12, 0xffff0000, v203
    v_mul_f32 v13, v171, v12
    v_mul_f32 v14, v139, v12
    v_fma_f32 v139, v139, v11, -v13
    v_fma_f32 v171, v171, v11, v14
    v_cvt_pk_bf16_f32 v14, v136, v137
    v_cvt_pk_bf16_f32 v15, v138, v139
    ds_write_b64 v45, v[14:15] offset:32
    v_cvt_pk_bf16_f32 v14, v168, v169
    v_cvt_pk_bf16_f32 v15, v170, v171
    ds_write_b64 v45, v[14:15] offset:96
    v_lshlrev_b32 v11, 16, v204
    v_lshlrev_b32 v12, 16, v206
    v_mul_f32 v13, v172, v12
    v_mul_f32 v14, v140, v12
    v_fma_f32 v140, v140, v11, -v13
    v_fma_f32 v172, v172, v11, v14
    v_and_b32 v11, 0xffff0000, v204
    v_and_b32 v12, 0xffff0000, v206
    v_mul_f32 v13, v173, v12
    v_mul_f32 v14, v141, v12
    v_fma_f32 v141, v141, v11, -v13
    v_fma_f32 v173, v173, v11, v14
    v_lshlrev_b32 v11, 16, v205
    v_lshlrev_b32 v12, 16, v207
    v_mul_f32 v13, v174, v12
    v_mul_f32 v14, v142, v12
    v_fma_f32 v142, v142, v11, -v13
    v_fma_f32 v174, v174, v11, v14
    v_and_b32 v11, 0xffff0000, v205
    v_and_b32 v12, 0xffff0000, v207
    v_mul_f32 v13, v175, v12
    v_mul_f32 v14, v143, v12
    v_fma_f32 v143, v143, v11, -v13
    v_fma_f32 v175, v175, v11, v14
    v_cvt_pk_bf16_f32 v14, v140, v141
    v_cvt_pk_bf16_f32 v15, v142, v143
    ds_write_b64 v45, v[14:15] offset:2336
    v_cvt_pk_bf16_f32 v14, v172, v173
    v_cvt_pk_bf16_f32 v15, v174, v175
    ds_write_b64 v45, v[14:15] offset:2400
    s_waitcnt lgkmcnt(0)
    ds_read_b128 v[16:19], v44 offset:0
    ds_read_b128 v[20:23], v44 offset:2304
    ds_read_b128 v[32:35], v44 offset:64
    ds_read_b128 v[36:39], v44 offset:2368
    s_waitcnt lgkmcnt(0)
    v_xor_b32 v48, 0x80008000, v32
    v_xor_b32 v49, 0x80008000, v33
    v_xor_b32 v50, 0x80008000, v34
    v_xor_b32 v51, 0x80008000, v35
    v_xor_b32 v52, 0x80008000, v36
    v_xor_b32 v53, 0x80008000, v37
    v_xor_b32 v54, 0x80008000, v38
    v_xor_b32 v55, 0x80008000, v39
    s_nop 1
    v_mfma_f32_16x16x32_bf16 v[128:131], v[16:19], v[208:211], 0
    v_mfma_f32_16x16x32_bf16 v[128:131], v[48:51], v[216:219], v[128:131]
    v_mfma_f32_16x16x32_bf16 v[160:163], v[32:35], v[208:211], 0
    v_mfma_f32_16x16x32_bf16 v[160:163], v[16:19], v[216:219], v[160:163]
    v_mfma_f32_16x16x32_bf16 v[132:135], v[16:19], v[212:215], 0
    v_mfma_f32_16x16x32_bf16 v[132:135], v[48:51], v[220:223], v[132:135]
    v_mfma_f32_16x16x32_bf16 v[164:167], v[32:35], v[212:215], 0
    v_mfma_f32_16x16x32_bf16 v[164:167], v[16:19], v[220:223], v[164:167]
    v_mfma_f32_16x16x32_bf16 v[136:139], v[20:23], v[208:211], 0
    v_mfma_f32_16x16x32_bf16 v[136:139], v[52:55], v[216:219], v[136:139]
    v_mfma_f32_16x16x32_bf16 v[168:171], v[36:39], v[208:211], 0
    v_mfma_f32_16x16x32_bf16 v[168:171], v[20:23], v[216:219], v[168:171]
    v_mfma_f32_16x16x32_bf16 v[140:143], v[20:23], v[212:215], 0
    v_mfma_f32_16x16x32_bf16 v[140:143], v[52:55], v[220:223], v[140:143]
    v_mfma_f32_16x16x32_bf16 v[172:175], v[36:39], v[212:215], 0
    v_mfma_f32_16x16x32_bf16 v[172:175], v[20:23], v[220:223], v[172:175]
    s_nop 7
    v_lshl_add_u32 v5, v1, 2, v3
    v_mul_u32_u24 v5, 272, v5
    v_lshl_add_u32 v5, v2, 3, v5
    v_lshl_add_u32 v5, v41, 6, v5
    v_add_u32 v11, 0, v1
    v_add_u32 v12, 0, v43
    v_mul_u32_u24 v11, v11, v12
    v_cvt_f32_u32 v11, v11
    v_mul_f32 v11, 0x3a000000, v11
    v_cos_f32 v12, v11
    v_sin_f32 v13, v11
    s_nop 0
    v_mul_f32 v14, v160, v13
    v_mul_f32 v15, v128, v13
    v_fma_f32 v128, v128, v12, -v14
    v_fma_f32 v160, v160, v12, v15
    v_add_u32 v11, 0, v1
    v_add_u32 v12, 1, v43
    v_mul_u32_u24 v11, v11, v12
    v_cvt_f32_u32 v11, v11
    v_mul_f32 v11, 0x3a000000, v11
    v_cos_f32 v12, v11
    v_sin_f32 v13, v11
    s_nop 0
    v_mul_f32 v14, v161, v13
    v_mul_f32 v15, v129, v13
    v_fma_f32 v129, v129, v12, -v14
    v_fma_f32 v161, v161, v12, v15
    v_add_u32 v11, 0, v1
    v_add_u32 v12, 2, v43
    v_mul_u32_u24 v11, v11, v12
    v_cvt_f32_u32 v11, v11
    v_mul_f32 v11, 0x3a000000, v11
    v_cos_f32 v12, v11
    v_sin_f32 v13, v11
    s_nop 0
    v_mul_f32 v14, v162, v13
    v_mul_f32 v15, v130, v13
    v_fma_f32 v130, v130, v12, -v14
    v_fma_f32 v162, v162, v12, v15
    v_add_u32 v11, 0, v1
    v_add_u32 v12, 3, v43
    v_mul_u32_u24 v11, v11, v12
    v_cvt_f32_u32 v11, v11
    v_mul_f32 v11, 0x3a000000, v11
    v_cos_f32 v12, v11
    v_sin_f32 v13, v11
    s_nop 0
    v_mul_f32 v14, v163, v13
    v_mul_f32 v15, v131, v13
    v_fma_f32 v131, v131, v12, -v14
    v_fma_f32 v163, v163, v12, v15
    v_cvt_pk_bf16_f32 v14, v128, v129
    v_cvt_pk_bf16_f32 v15, v130, v131
    ds_write_b64 v5, v[14:15] offset:36864
    v_cvt_pk_bf16_f32 v14, v160, v161
    v_cvt_pk_bf16_f32 v15, v162, v163
    ds_write_b64 v5, v[14:15] offset:36992
    v_add_u32 v11, 16, v1
    v_add_u32 v12, 0, v43
    v_mul_u32_u24 v11, v11, v12
    v_cvt_f32_u32 v11, v11
    v_mul_f32 v11, 0x3a000000, v11
    v_cos_f32 v12, v11
    v_sin_f32 v13, v11
    s_nop 0
    v_mul_f32 v14, v164, v13
    v_mul_f32 v15, v132, v13
    v_fma_f32 v132, v132, v12, -v14
    v_fma_f32 v164, v164, v12, v15
    v_add_u32 v11, 16, v1
    v_add_u32 v12, 1, v43
    v_mul_u32_u24 v11, v11, v12
    v_cvt_f32_u32 v11, v11
    v_mul_f32 v11, 0x3a000000, v11
    v_cos_f32 v12, v11
    v_sin_f32 v13, v11
    s_nop 0
    v_mul_f32 v14, v165, v13
    v_mul_f32 v15, v133, v13
    v_fma_f32 v133, v133, v12, -v14
    v_fma_f32 v165, v165, v12, v15
    v_add_u32 v11, 16, v1
    v_add_u32 v12, 2, v43
    v_mul_u32_u24 v11, v11, v12
    v_cvt_f32_u32 v11, v11
    v_mul_f32 v11, 0x3a000000, v11
    v_cos_f32 v12, v11
    v_sin_f32 v13, v11
    s_nop 0
    v_mul_f32 v14, v166, v13
    v_mul_f32 v15, v134, v13
    v_fma_f32 v134, v134, v12, -v14
    v_fma_f32 v166, v166, v12, v15
    v_add_u32 v11, 16, v1
    v_add_u32 v12, 3, v43
    v_mul_u32_u24 v11, v11, v12
    v_cvt_f32_u32 v11, v11
    v_mul_f32 v11, 0x3a000000, v11
    v_cos_f32 v12, v11
    v_sin_f32 v13, v11
    s_nop 0
    v_mul_f32 v14, v167, v13
    v_mul_f32 v15, v135, v13
    v_fma_f32 v135, v135, v12, -v14
    v_fma_f32 v167, v167, v12, v15
    v_cvt_pk_bf16_f32 v14, v132, v133
    v_cvt_pk_bf16_f32 v15, v134, v135
    ds_write_b64 v5, v[14:15] offset:54272
    v_cvt_pk_bf16_f32 v14, v164, v165
    v_cvt_pk_bf16_f32 v15, v166, v167
    ds_write_b64 v5, v[14:15] offset:54400
    v_add_u32 v11, 0, v1
    v_add_u32 v12, 16, v43
    v_mul_u32_u24 v11, v11, v12
    v_cvt_f32_u32 v11, v11
    v_mul_f32 v11, 0x3a000000, v11
    v_cos_f32 v12, v11
    v_sin_f32 v13, v11
    s_nop 0
    v_mul_f32 v14, v168, v13
    v_mul_f32 v15, v136, v13
    v_fma_f32 v136, v136, v12, -v14
    v_fma_f32 v168, v168, v12, v15
    v_add_u32 v11, 0, v1
    v_add_u32 v12, 17, v43
    v_mul_u32_u24 v11, v11, v12
    v_cvt_f32_u32 v11, v11
    v_mul_f32 v11, 0x3a000000, v11
    v_cos_f32 v12, v11
    v_sin_f32 v13, v11
    s_nop 0
    v_mul_f32 v14, v169, v13
    v_mul_f32 v15, v137, v13
    v_fma_f32 v137, v137, v12, -v14
    v_fma_f32 v169, v169, v12, v15
    v_add_u32 v11, 0, v1
    v_add_u32 v12, 18, v43
    v_mul_u32_u24 v11, v11, v12
    v_cvt_f32_u32 v11, v11
    v_mul_f32 v11, 0x3a000000, v11
    v_cos_f32 v12, v11
    v_sin_f32 v13, v11
    s_nop 0
    v_mul_f32 v14, v170, v13
    v_mul_f32 v15, v138, v13
    v_fma_f32 v138, v138, v12, -v14
    v_fma_f32 v170, v170, v12, v15
    v_add_u32 v11, 0, v1
    v_add_u32 v12, 19, v43
    v_mul_u32_u24 v11, v11, v12
    v_cvt_f32_u32 v11, v11
    v_mul_f32 v11, 0x3a000000, v11
    v_cos_f32 v12, v11
    v_sin_f32 v13, v11
    s_nop 0
    v_mul_f32 v14, v171, v13
    v_mul_f32 v15, v139, v13
    v_fma_f32 v139, v139, v12, -v14
    v_fma_f32 v171, v171, v12, v15
    v_cvt_pk_bf16_f32 v14, v136, v137
    v_cvt_pk_bf16_f32 v15, v138, v139
    ds_write_b64 v5, v[14:15] offset:36896
    v_cvt_pk_bf16_f32 v14, v168, v169
    v_cvt_pk_bf16_f32 v15, v170, v171
    ds_write_b64 v5, v[14:15] offset:37024
    v_add_u32 v11, 16, v1
    v_add_u32 v12, 16, v43
    v_mul_u32_u24 v11, v11, v12
    v_cvt_f32_u32 v11, v11
    v_mul_f32 v11, 0x3a000000, v11
    v_cos_f32 v12, v11
    v_sin_f32 v13, v11
    s_nop 0
    v_mul_f32 v14, v172, v13
    v_mul_f32 v15, v140, v13
    v_fma_f32 v140, v140, v12, -v14
    v_fma_f32 v172, v172, v12, v15
    v_add_u32 v11, 16, v1
    v_add_u32 v12, 17, v43
    v_mul_u32_u24 v11, v11, v12
    v_cvt_f32_u32 v11, v11
    v_mul_f32 v11, 0x3a000000, v11
    v_cos_f32 v12, v11
    v_sin_f32 v13, v11
    s_nop 0
    v_mul_f32 v14, v173, v13
    v_mul_f32 v15, v141, v13
    v_fma_f32 v141, v141, v12, -v14
    v_fma_f32 v173, v173, v12, v15
    v_add_u32 v11, 16, v1
    v_add_u32 v12, 18, v43
    v_mul_u32_u24 v11, v11, v12
    v_cvt_f32_u32 v11, v11
    v_mul_f32 v11, 0x3a000000, v11
    v_cos_f32 v12, v11
    v_sin_f32 v13, v11
    s_nop 0
    v_mul_f32 v14, v174, v13
    v_mul_f32 v15, v142, v13
    v_fma_f32 v142, v142, v12, -v14
    v_fma_f32 v174, v174, v12, v15
    v_add_u32 v11, 16, v1
    v_add_u32 v12, 19, v43
    v_mul_u32_u24 v11, v11, v12
    v_cvt_f32_u32 v11, v11
    v_mul_f32 v11, 0x3a000000, v11
    v_cos_f32 v12, v11
    v_sin_f32 v13, v11
    s_nop 0
    v_mul_f32 v14, v175, v13
    v_mul_f32 v15, v143, v13
    v_fma_f32 v143, v143, v12, -v14
    v_fma_f32 v175, v175, v12, v15
    v_cvt_pk_bf16_f32 v14, v140, v141
    v_cvt_pk_bf16_f32 v15, v142, v143
    ds_write_b64 v5, v[14:15] offset:54304
    v_cvt_pk_bf16_f32 v14, v172, v173
    v_cvt_pk_bf16_f32 v15, v174, v175
    ds_write_b64 v5, v[14:15] offset:54432
    s_waitcnt lgkmcnt(0)
    s_barrier
    v_lshrrev_b32 v46, 6, v0
    v_lshl_add_u32 v5, v46, 4, v1
    v_mul_u32_u24 v5, 272, v5
    v_lshl_add_u32 v5, v2, 4, v5
    ds_read_b128 v[16:19], v5 offset:36864
    ds_read_b128 v[20:23], v5 offset:36928
    ds_read_b128 v[32:35], v5 offset:36992
    ds_read_b128 v[36:39], v5 offset:37056
    s_waitcnt lgkmcnt(0)
    v_xor_b32 v48, 0x80008000, v32
    v_xor_b32 v49, 0x80008000, v33
    v_xor_b32 v50, 0x80008000, v34
    v_xor_b32 v51, 0x80008000, v35
    v_xor_b32 v52, 0x80008000, v36
    v_xor_b32 v53, 0x80008000, v37
    v_xor_b32 v54, 0x80008000, v38
    v_xor_b32 v55, 0x80008000, v39
    s_nop 1
    v_mfma_f32_16x16x32_bf16 v[128:131], v[16:19], v[64:67], 0
    v_mfma_f32_16x16x32_bf16 v[128:131], v[48:51], v[96:99], v[128:131]
    v_mfma_f32_16x16x32_bf16 v[160:163], v[32:35], v[64:67], 0
    v_mfma_f32_16x16x32_bf16 v[160:163], v[16:19], v[96:99], v[160:163]
    v_mfma_f32_16x16x32_bf16 v[128:131], v[20:23], v[68:71], v[128:131]
    v_mfma_f32_16x16x32_bf16 v[128:131], v[52:55], v[100:103], v[128:131]
    v_mfma_f32_16x16x32_bf16 v[160:163], v[36:39], v[68:71], v[160:163]
    v_mfma_f32_16x16x32_bf16 v[160:163], v[20:23], v[100:103], v[160:163]
    v_mfma_f32_16x16x32_bf16 v[132:135], v[16:19], v[72:75], 0
    v_mfma_f32_16x16x32_bf16 v[132:135], v[48:51], v[104:107], v[132:135]
    v_mfma_f32_16x16x32_bf16 v[164:167], v[32:35], v[72:75], 0
    v_mfma_f32_16x16x32_bf16 v[164:167], v[16:19], v[104:107], v[164:167]
    v_mfma_f32_16x16x32_bf16 v[132:135], v[20:23], v[76:79], v[132:135]
    v_mfma_f32_16x16x32_bf16 v[132:135], v[52:55], v[108:111], v[132:135]
    v_mfma_f32_16x16x32_bf16 v[164:167], v[36:39], v[76:79], v[164:167]
    v_mfma_f32_16x16x32_bf16 v[164:167], v[20:23], v[108:111], v[164:167]
    v_mfma_f32_16x16x32_bf16 v[136:139], v[16:19], v[80:83], 0
    v_mfma_f32_16x16x32_bf16 v[136:139], v[48:51], v[112:115], v[136:139]
    v_mfma_f32_16x16x32_bf16 v[168:171], v[32:35], v[80:83], 0
    v_mfma_f32_16x16x32_bf16 v[168:171], v[16:19], v[112:115], v[168:171]
    v_mfma_f32_16x16x32_bf16 v[136:139], v[20:23], v[84:87], v[136:139]
    v_mfma_f32_16x16x32_bf16 v[136:139], v[52:55], v[116:119], v[136:139]
    v_mfma_f32_16x16x32_bf16 v[168:171], v[36:39], v[84:87], v[168:171]
    v_mfma_f32_16x16x32_bf16 v[168:171], v[20:23], v[116:119], v[168:171]
    v_mfma_f32_16x16x32_bf16 v[140:143], v[16:19], v[88:91], 0
    v_mfma_f32_16x16x32_bf16 v[140:143], v[48:51], v[120:123], v[140:143]
    v_mfma_f32_16x16x32_bf16 v[172:175], v[32:35], v[88:91], 0
    v_mfma_f32_16x16x32_bf16 v[172:175], v[16:19], v[120:123], v[172:175]
    v_mfma_f32_16x16x32_bf16 v[140:143], v[20:23], v[92:95], v[140:143]
    v_mfma_f32_16x16x32_bf16 v[140:143], v[52:55], v[124:127], v[140:143]
    v_mfma_f32_16x16x32_bf16 v[172:175], v[36:39], v[92:95], v[172:175]
    v_mfma_f32_16x16x32_bf16 v[172:175], v[20:23], v[124:127], v[172:175]
    s_nop 7
    v_lshlrev_b32 v5, 5, v1
    v_lshl_add_u32 v5, v46, 2, v5
    v_add_u32 v5, v5, v2
    v_lshlrev_b32 v5, 4, v5
    s_lshl_b32 s3, s2, 15
    v_add_u32 v5, s3, v5
    v_cvt_pk_bf16_f32 v16, v128, v129
    v_cvt_pk_bf16_f32 v17, v130, v131
    v_cvt_pk_bf16_f32 v18, v160, v161
    v_cvt_pk_bf16_f32 v19, v162, v163
    v_add_u32 v6, 0, v5
    buffer_store_dwordx4 v[16:19], v6, s[44:47], 0 offen
    v_cvt_pk_bf16_f32 v20, v132, v133
    v_cvt_pk_bf16_f32 v21, v134, v135
    v_cvt_pk_bf16_f32 v22, v164, v165
    v_cvt_pk_bf16_f32 v23, v166, v167
    v_add_u32 v6, 8192, v5
    buffer_store_dwordx4 v[20:23], v6, s[44:47], 0 offen
    v_cvt_pk_bf16_f32 v24, v136, v137
    v_cvt_pk_bf16_f32 v25, v138, v139
    v_cvt_pk_bf16_f32 v26, v168, v169
    v_cvt_pk_bf16_f32 v27, v170, v171
    v_add_u32 v6, 16384, v5
    buffer_store_dwordx4 v[24:27], v6, s[44:47], 0 offen
    v_cvt_pk_bf16_f32 v28, v140, v141
    v_cvt_pk_bf16_f32 v29, v142, v143
    v_cvt_pk_bf16_f32 v30, v172, v173
    v_cvt_pk_bf16_f32 v31, v174, v175
    v_add_u32 v6, 24576, v5
    buffer_store_dwordx4 v[28:31], v6, s[44:47], 0 offen
col_end:
    s_endpgm
.section .rodata,"a"
.p2align 6
.amdhsa_kernel col_kernel
  .amdhsa_next_free_vgpr 224
  .amdhsa_next_free_sgpr 100
  .amdhsa_accum_offset 224
  .amdhsa_group_segment_fixed_size 0
  .amdhsa_kernarg_size 88
  .amdhsa_user_sgpr_count 2
  .amdhsa_user_sgpr_kernarg_segment_ptr 1
  .amdhsa_system_sgpr_workgroup_id_x 1
.end_amdhsa_kernel
.text
.globl idft0_kernel
.p2align 8
.type idft0_kernel,@function
idft0_kernel:
    s_load_dwordx4 s[4:7], s[0:1], 0
    s_load_dwordx2 s[8:9], s[0:1], 16
    s_load_dwordx4 s[12:15], s[0:1], 32
    s_load_dwordx4 s[16:19], s[0:1], 48
    s_load_dwordx2 s[20:21], s[0:1], 64
    s_load_dwordx2 s[24:25], s[0:1], 80
    s_waitcnt lgkmcnt(0)
    s_cmp_ge_u32 s2, 160
    s_cbranch_scc1 idft0_kernel_end
    s_and_b32 s36, s2, 15
    s_lshr_b32 s37, s2, 4
    s_add_u32 s28, s24, 13631488
    s_addc_u32 s29, s25, 0
    s_mov_b32 s30, 2752512
    s_mov_b32 s31, 0x00020000
    s_add_u32 s32, s24, 5373952
    s_addc_u32 s33, s25, 0
    s_mov_b32 s34, 860160
    s_mov_b32 s35, 0x00020000
    v_lshrrev_b32 v1, 3, v0
    v_and_b32 v2, 7, v0
    s_mov_b32 s38, 32768
    v_mul_lo_u32 v23, v2, s38
    v_lshlrev_b32 v2, 4, v2
    v_mul_u32_u24 v3, 160, v1
    v_add_u32 v3, v3, v2
    s_mul_i32 s38, s36, 128
    v_add_u32 v4, 0, v1
    v_add_u32 v4, s38, v4
    s_mov_b32 s38, 16
    v_mul_lo_u32 v4, v4, s38
    v_add_u32 v10, v4, v23
    s_mul_i32 s38, s36, 128
    v_add_u32 v4, 64, v1
    v_add_u32 v4, s38, v4
    s_mov_b32 s38, 16
    v_mul_lo_u32 v4, v4, s38
    v_add_u32 v11, v4, v23
    s_mul_i32 s38, s37, 64
    v_add_u32 v4, 0, v1
    v_add_u32 v4, s38, v4
    s_mov_b32 s38, 1344
    v_mul_lo_u32 v4, v4, s38
    v_add_u32 v12, v4, v2
    v_and_b32 v5, 15, v0
    v_bfe_u32 v6, v0, 4, 2
    v_bfe_u32 v7, v0, 6, 2
    v_lshrrev_b32 v8, 8, v0
    v_lshlrev_b32 v9, 5, v7
    v_add_u32 v9, v9, v5
    v_mul_u32_u24 v20, 160, v9
    v_lshl_add_u32 v20, v6, 4, v20
    v_mul_u32_u24 v9, 32, v8
    v_add_u32 v9, v9, v5
    v_add_u32 v9, 128, v9
    v_mul_u32_u24 v21, 160, v9
    v_lshl_add_u32 v21, v6, 4, v21
    v_add_u32 v22, 30720, v3
    s_mov_b32 s39, 0
    s_mov_b32 s52, 0
    buffer_load_dwordx4 v[24:27], v10, s[28:31], s39 offen
    buffer_load_dwordx4 v[28:31], v11, s[28:31], s39 offen
    buffer_load_dwordx4 v[32:35], v12, s[32:35], s52 offen
    s_add_u32 s39, s39, 262144
    s_add_u32 s52, s52, 128
    buffer_load_dwordx4 v[36:39], v10, s[28:31], s39 offen
    buffer_load_dwordx4 v[40:43], v11, s[28:31], s39 offen
    buffer_load_dwordx4 v[44:47], v12, s[32:35], s52 offen
    v_mov_b32 v80, 0
    v_mov_b32 v81, 0
    v_mov_b32 v82, 0
    v_mov_b32 v83, 0
    v_mov_b32 v84, 0
    v_mov_b32 v85, 0
    v_mov_b32 v86, 0
    v_mov_b32 v87, 0
    v_mov_b32 v88, 0
    v_mov_b32 v89, 0
    v_mov_b32 v90, 0
    v_mov_b32 v91, 0
    v_mov_b32 v92, 0
    v_mov_b32 v93, 0
    v_mov_b32 v94, 0
    v_mov_b32 v95, 0
    s_waitcnt vmcnt(3)
    ds_write_b128 v3, v[24:27] offset:0
    ds_write_b128 v3, v[28:31] offset:10240
    ds_write_b128 v3, v[32:35] offset:20480
    s_waitcnt lgkmcnt(0)
    s_barrier
    s_mov_b32 s53, 4
idft0_kernel_loop:
    s_add_u32 s39, s39, 262144
    s_add_u32 s52, s52, 128
    buffer_load_dwordx4 v[24:27], v10, s[28:31], s39 offen
    buffer_load_dwordx4 v[28:31], v11, s[28:31], s39 offen
    buffer_load_dwordx4 v[32:35], v12, s[32:35], s52 offen
    ds_read_b128 v[48:51], v20 offset:0
    ds_read_b128 v[52:55], v20 offset:2560
    ds_read_b128 v[56:59], v21 offset:0
    ds_read_b128 v[60:63], v21 offset:2560
    ds_read_b128 v[64:67], v20 offset:64
    ds_read_b128 v[68:71], v20 offset:2624
    ds_read_b128 v[72:75], v21 offset:64
    ds_read_b128 v[76:79], v21 offset:2624
    s_waitcnt vmcnt(3)
    ds_write_b128 v22, v[36:39] offset:0
    ds_write_b128 v22, v[40:43] offset:10240
    ds_write_b128 v22, v[44:47] offset:20480
    s_waitcnt lgkmcnt(7)
    v_mfma_f32_16x16x32_bf16 v[80:83], v[56:59], v[48:51], v[80:83]
    v_mfma_f32_16x16x32_bf16 v[84:87], v[60:63], v[48:51], v[84:87]
    v_mfma_f32_16x16x32_bf16 v[88:91], v[56:59], v[52:55], v[88:91]
    v_mfma_f32_16x16x32_bf16 v[92:95], v[60:63], v[52:55], v[92:95]
    s_waitcnt lgkmcnt(3)
    v_mfma_f32_16x16x32_bf16 v[80:83], v[72:75], v[64:67], v[80:83]
    v_mfma_f32_16x16x32_bf16 v[84:87], v[76:79], v[64:67], v[84:87]
    v_mfma_f32_16x16x32_bf16 v[88:91], v[72:75], v[68:71], v[88:91]
    v_mfma_f32_16x16x32_bf16 v[92:95], v[76:79], v[68:71], v[92:95]
    s_waitcnt lgkmcnt(0)
    s_barrier
    s_add_u32 s39, s39, 262144
    s_add_u32 s52, s52, 128
    buffer_load_dwordx4 v[36:39], v10, s[28:31], s39 offen
    buffer_load_dwordx4 v[40:43], v11, s[28:31], s39 offen
    buffer_load_dwordx4 v[44:47], v12, s[32:35], s52 offen
    ds_read_b128 v[48:51], v20 offset:30720
    ds_read_b128 v[52:55], v20 offset:33280
    ds_read_b128 v[56:59], v21 offset:30720
    ds_read_b128 v[60:63], v21 offset:33280
    ds_read_b128 v[64:67], v20 offset:30784
    ds_read_b128 v[68:71], v20 offset:33344
    ds_read_b128 v[72:75], v21 offset:30784
    ds_read_b128 v[76:79], v21 offset:33344
    s_waitcnt vmcnt(3)
    ds_write_b128 v3, v[24:27] offset:0
    ds_write_b128 v3, v[28:31] offset:10240
    ds_write_b128 v3, v[32:35] offset:20480
    s_waitcnt lgkmcnt(7)
    v_mfma_f32_16x16x32_bf16 v[80:83], v[56:59], v[48:51], v[80:83]
    v_mfma_f32_16x16x32_bf16 v[84:87], v[60:63], v[48:51], v[84:87]
    v_mfma_f32_16x16x32_bf16 v[88:91], v[56:59], v[52:55], v[88:91]
    v_mfma_f32_16x16x32_bf16 v[92:95], v[60:63], v[52:55], v[92:95]
    s_waitcnt lgkmcnt(3)
    v_mfma_f32_16x16x32_bf16 v[80:83], v[72:75], v[64:67], v[80:83]
    v_mfma_f32_16x16x32_bf16 v[84:87], v[76:79], v[64:67], v[84:87]
    v_mfma_f32_16x16x32_bf16 v[88:91], v[72:75], v[68:71], v[88:91]
    v_mfma_f32_16x16x32_bf16 v[92:95], v[76:79], v[68:71], v[92:95]
    s_waitcnt lgkmcnt(0)
    s_barrier
    s_sub_u32 s53, s53, 1
    s_cmp_lg_u32 s53, 0
    s_cbranch_scc1 idft0_kernel_loop
    s_add_u32 s39, s39, 262144
    s_add_u32 s52, s52, 128
    buffer_load_dwordx4 v[24:27], v10, s[28:31], s39 offen
    buffer_load_dwordx4 v[28:31], v11, s[28:31], s39 offen
    buffer_load_dwordx4 v[32:35], v12, s[32:35], s52 offen
    ds_read_b128 v[48:51], v20 offset:0
    ds_read_b128 v[52:55], v20 offset:2560
    ds_read_b128 v[56:59], v21 offset:0
    ds_read_b128 v[60:63], v21 offset:2560
    ds_read_b128 v[64:67], v20 offset:64
    ds_read_b128 v[68:71], v20 offset:2624
    ds_read_b128 v[72:75], v21 offset:64
    ds_read_b128 v[76:79], v21 offset:2624
    s_waitcnt vmcnt(3)
    ds_write_b128 v22, v[36:39] offset:0
    ds_write_b128 v22, v[40:43] offset:10240
    ds_write_b128 v22, v[44:47] offset:20480
    s_waitcnt lgkmcnt(7)
    v_mfma_f32_16x16x32_bf16 v[80:83], v[56:59], v[48:51], v[80:83]
    v_mfma_f32_16x16x32_bf16 v[84:87], v[60:63], v[48:51], v[84:87]
    v_mfma_f32_16x16x32_bf16 v[88:91], v[56:59], v[52:55], v[88:91]
    v_mfma_f32_16x16x32_bf16 v[92:95], v[60:63], v[52:55], v[92:95]
    s_waitcnt lgkmcnt(3)
    v_mfma_f32_16x16x32_bf16 v[80:83], v[72:75], v[64:67], v[80:83]
    v_mfma_f32_16x16x32_bf16 v[84:87], v[76:79], v[64:67], v[84:87]
    v_mfma_f32_16x16x32_bf16 v[88:91], v[72:75], v[68:71], v[88:91]
    v_mfma_f32_16x16x32_bf16 v[92:95], v[76:79], v[68:71], v[92:95]
    s_waitcnt lgkmcnt(0)
    s_barrier
    ds_read_b128 v[48:51], v20 offset:30720
    ds_read_b128 v[52:55], v20 offset:33280
    ds_read_b128 v[56:59], v21 offset:30720
    ds_read_b128 v[60:63], v21 offset:33280
    ds_read_b128 v[64:67], v20 offset:30784
    ds_read_b128 v[68:71], v20 offset:33344
    ds_read_b128 v[72:75], v21 offset:30784
    ds_read_b128 v[76:79], v21 offset:33344
    s_waitcnt vmcnt(0)
    ds_write_b128 v3, v[24:27] offset:0
    ds_write_b128 v3, v[28:31] offset:10240
    ds_write_b128 v3, v[32:35] offset:20480
    s_waitcnt lgkmcnt(7)
    v_mfma_f32_16x16x32_bf16 v[80:83], v[56:59], v[48:51], v[80:83]
    v_mfma_f32_16x16x32_bf16 v[84:87], v[60:63], v[48:51], v[84:87]
    v_mfma_f32_16x16x32_bf16 v[88:91], v[56:59], v[52:55], v[88:91]
    v_mfma_f32_16x16x32_bf16 v[92:95], v[60:63], v[52:55], v[92:95]
    s_waitcnt lgkmcnt(3)
    v_mfma_f32_16x16x32_bf16 v[80:83], v[72:75], v[64:67], v[80:83]
    v_mfma_f32_16x16x32_bf16 v[84:87], v[76:79], v[64:67], v[84:87]
    v_mfma_f32_16x16x32_bf16 v[88:91], v[72:75], v[68:71], v[88:91]
    v_mfma_f32_16x16x32_bf16 v[92:95], v[76:79], v[68:71], v[92:95]
    s_waitcnt lgkmcnt(0)
    s_barrier
    ds_read_b128 v[48:51], v20 offset:0
    ds_read_b128 v[52:55], v20 offset:2560
    ds_read_b128 v[56:59], v21 offset:0
    ds_read_b128 v[60:63], v21 offset:2560
    s_waitcnt lgkmcnt(0)
    v_mfma_f32_16x16x32_bf16 v[80:83], v[56:59], v[48:51], v[80:83]
    v_mfma_f32_16x16x32_bf16 v[84:87], v[60:63], v[48:51], v[84:87]
    v_mfma_f32_16x16x32_bf16 v[88:91], v[56:59], v[52:55], v[88:91]
    v_mfma_f32_16x16x32_bf16 v[92:95], v[60:63], v[52:55], v[92:95]
    s_nop 15
    s_mul_i32 s38, s37, 64
    v_mul_u32_u24 v9, 32, v8
    v_add_u32 v9, s38, v9
    v_lshlrev_b32 v1, 5, v7
    s_add_u32 s40, s24, 25165824
    s_addc_u32 s41, s25, 0
    s_mov_b32 s42, 8388608
    s_mov_b32 s43, 0x00020000
    v_lshl_add_u32 v9, v6, 2, v9
    v_add_u32 v1, v1, v5
    s_mul_i32 s38, s36, 128
    v_add_u32 v1, s38, v1
    s_mov_b32 s38, 1280
    v_mul_lo_u32 v2, v1, s38
    v_lshl_add_u32 v2, v9, 1, v2
    v_add_u32 v4, 20480, v2
    s_add_u32 s48, s4, 0
    s_addc_u32 s49, s5, 0
    s_mov_b32 s50, 2621440
    s_mov_b32 s51, 0x00020000
    buffer_load_dwordx2 v[40:41], v2, s[48:51], 0 offen offset:0
    buffer_load_dwordx2 v[42:43], v2, s[48:51], 0 offen offset:32
    buffer_load_dwordx2 v[44:45], v4, s[48:51], 0 offen offset:0
    buffer_load_dwordx2 v[46:47], v4, s[48:51], 0 offen offset:32
    s_waitcnt vmcnt(0)
    v_mul_f32 v80, 0x354ccccd, v80
    v_cvt_pk_bf16_f32 v80, v80, v80
    v_lshlrev_b32 v80, 16, v80
    v_lshlrev_b32 v10, 16, v40
    v_add_f32 v80, v80, v10
    v_mul_f32 v81, 0x354ccccd, v81
    v_cvt_pk_bf16_f32 v81, v81, v81
    v_lshlrev_b32 v81, 16, v81
    v_and_b32 v10, 0xffff0000, v40
    v_add_f32 v81, v81, v10
    v_mul_f32 v82, 0x354ccccd, v82
    v_cvt_pk_bf16_f32 v82, v82, v82
    v_lshlrev_b32 v82, 16, v82
    v_lshlrev_b32 v10, 16, v41
    v_add_f32 v82, v82, v10
    v_mul_f32 v83, 0x354ccccd, v83
    v_cvt_pk_bf16_f32 v83, v83, v83
    v_lshlrev_b32 v83, 16, v83
    v_and_b32 v10, 0xffff0000, v41
    v_add_f32 v83, v83, v10
    v_cvt_pk_bf16_f32 v80, v80, v81
    v_cvt_pk_bf16_f32 v81, v82, v83
    buffer_store_dwordx2 v[80:81], v2, s[40:43], 0 offen offset:0
    v_mul_f32 v84, 0x354ccccd, v84
    v_cvt_pk_bf16_f32 v84, v84, v84
    v_lshlrev_b32 v84, 16, v84
    v_lshlrev_b32 v10, 16, v42
    v_add_f32 v84, v84, v10
    v_mul_f32 v85, 0x354ccccd, v85
    v_cvt_pk_bf16_f32 v85, v85, v85
    v_lshlrev_b32 v85, 16, v85
    v_and_b32 v10, 0xffff0000, v42
    v_add_f32 v85, v85, v10
    v_mul_f32 v86, 0x354ccccd, v86
    v_cvt_pk_bf16_f32 v86, v86, v86
    v_lshlrev_b32 v86, 16, v86
    v_lshlrev_b32 v10, 16, v43
    v_add_f32 v86, v86, v10
    v_mul_f32 v87, 0x354ccccd, v87
    v_cvt_pk_bf16_f32 v87, v87, v87
    v_lshlrev_b32 v87, 16, v87
    v_and_b32 v10, 0xffff0000, v43
    v_add_f32 v87, v87, v10
    v_cvt_pk_bf16_f32 v84, v84, v85
    v_cvt_pk_bf16_f32 v85, v86, v87
    buffer_store_dwordx2 v[84:85], v2, s[40:43], 0 offen offset:32
    v_mul_f32 v88, 0x354ccccd, v88
    v_cvt_pk_bf16_f32 v88, v88, v88
    v_lshlrev_b32 v88, 16, v88
    v_lshlrev_b32 v10, 16, v44
    v_add_f32 v88, v88, v10
    v_mul_f32 v89, 0x354ccccd, v89
    v_cvt_pk_bf16_f32 v89, v89, v89
    v_lshlrev_b32 v89, 16, v89
    v_and_b32 v10, 0xffff0000, v44
    v_add_f32 v89, v89, v10
    v_mul_f32 v90, 0x354ccccd, v90
    v_cvt_pk_bf16_f32 v90, v90, v90
    v_lshlrev_b32 v90, 16, v90
    v_lshlrev_b32 v10, 16, v45
    v_add_f32 v90, v90, v10
    v_mul_f32 v91, 0x354ccccd, v91
    v_cvt_pk_bf16_f32 v91, v91, v91
    v_lshlrev_b32 v91, 16, v91
    v_and_b32 v10, 0xffff0000, v45
    v_add_f32 v91, v91, v10
    v_cvt_pk_bf16_f32 v88, v88, v89
    v_cvt_pk_bf16_f32 v89, v90, v91
    buffer_store_dwordx2 v[88:89], v4, s[40:43], 0 offen offset:0
    v_mul_f32 v92, 0x354ccccd, v92
    v_cvt_pk_bf16_f32 v92, v92, v92
    v_lshlrev_b32 v92, 16, v92
    v_lshlrev_b32 v10, 16, v46
    v_add_f32 v92, v92, v10
    v_mul_f32 v93, 0x354ccccd, v93
    v_cvt_pk_bf16_f32 v93, v93, v93
    v_lshlrev_b32 v93, 16, v93
    v_and_b32 v10, 0xffff0000, v46
    v_add_f32 v93, v93, v10
    v_mul_f32 v94, 0x354ccccd, v94
    v_cvt_pk_bf16_f32 v94, v94, v94
    v_lshlrev_b32 v94, 16, v94
    v_lshlrev_b32 v10, 16, v47
    v_add_f32 v94, v94, v10
    v_mul_f32 v95, 0x354ccccd, v95
    v_cvt_pk_bf16_f32 v95, v95, v95
    v_lshlrev_b32 v95, 16, v95
    v_and_b32 v10, 0xffff0000, v47
    v_add_f32 v95, v95, v10
    v_cvt_pk_bf16_f32 v92, v92, v93
    v_cvt_pk_bf16_f32 v93, v94, v95
    buffer_store_dwordx2 v[92:93], v4, s[40:43], 0 offen offset:32
idft0_kernel_end:
    s_endpgm
.section .rodata,"a"
.p2align 6
.amdhsa_kernel idft0_kernel
  .amdhsa_next_free_vgpr 96
  .amdhsa_next_free_sgpr 100
  .amdhsa_accum_offset 96
  .amdhsa_group_segment_fixed_size 0
  .amdhsa_kernarg_size 88
  .amdhsa_user_sgpr_count 2
  .amdhsa_user_sgpr_kernarg_segment_ptr 1
  .amdhsa_system_sgpr_workgroup_id_x 1
.end_amdhsa_kernel
.text
.globl idft1_kernel
.p2align 8
.type idft1_kernel,@function
idft1_kernel:
    s_load_dwordx4 s[4:7], s[0:1], 0
    s_load_dwordx2 s[8:9], s[0:1], 16
    s_load_dwordx4 s[12:15], s[0:1], 32
    s_load_dwordx4 s[16:19], s[0:1], 48
    s_load_dwordx2 s[20:21], s[0:1], 64
    s_load_dwordx2 s[24:25], s[0:1], 80
    s_waitcnt lgkmcnt(0)
    s_cmp_ge_u32 s2, 160
    s_cbranch_scc1 idft1_kernel_end
    s_and_b32 s36, s2, 15
    s_lshr_b32 s37, s2, 4
    s_add_u32 s28, s24, 13631488
    s_addc_u32 s29, s25, 0
    s_mov_b32 s30, 2752512
    s_mov_b32 s31, 0x00020000
    s_add_u32 s32, s24, 5373952
    s_addc_u32 s33, s25, 0
    s_mov_b32 s34, 860160
    s_mov_b32 s35, 0x00020000
    v_lshrrev_b32 v1, 3, v0
    v_and_b32 v2, 7, v0
    s_mov_b32 s38, 32768
    v_mul_lo_u32 v23, v2, s38
    v_lshlrev_b32 v2, 4, v2
    v_mul_u32_u24 v3, 160, v1
    v_add_u32 v3, v3, v2
    s_mul_i32 s38, s36, 128
    v_add_u32 v4, 0, v1
    v_add_u32 v4, s38, v4
    s_mov_b32 s38, 16
    v_mul_lo_u32 v4, v4, s38
    v_add_u32 v10, v4, v23
    s_mul_i32 s38, s36, 128
    v_add_u32 v4, 64, v1
    v_add_u32 v4, s38, v4
    s_mov_b32 s38, 16
    v_mul_lo_u32 v4, v4, s38
    v_add_u32 v11, v4, v23
    s_mul_i32 s38, s37, 64
    v_add_u32 v4, 0, v1
    v_add_u32 v4, s38, v4
    s_mov_b32 s38, 1344
    v_mul_lo_u32 v4, v4, s38
    v_add_u32 v12, v4, v2
    v_and_b32 v5, 15, v0
    v_bfe_u32 v6, v0, 4, 2
    v_bfe_u32 v7, v0, 6, 2
    v_lshrrev_b32 v8, 8, v0
    v_lshlrev_b32 v9, 5, v7
    v_add_u32 v9, v9, v5
    v_mul_u32_u24 v20, 160, v9
    v_lshl_add_u32 v20, v6, 4, v20
    v_mul_u32_u24 v9, 32, v8
    v_add_u32 v9, v9, v5
    v_add_u32 v9, 128, v9
    v_mul_u32_u24 v21, 160, v9
    v_lshl_add_u32 v21, v6, 4, v21
    v_add_u32 v22, 30720, v3
    s_mov_b32 s39, 0
    s_mov_b32 s52, 0
    buffer_load_dwordx4 v[24:27], v10, s[28:31], s39 offen
    buffer_load_dwordx4 v[28:31], v11, s[28:31], s39 offen
    buffer_load_dwordx4 v[32:35], v12, s[32:35], s52 offen
    s_add_u32 s39, s39, 262144
    s_add_u32 s52, s52, 128
    buffer_load_dwordx4 v[36:39], v10, s[28:31], s39 offen
    buffer_load_dwordx4 v[40:43], v11, s[28:31], s39 offen
    buffer_load_dwordx4 v[44:47], v12, s[32:35], s52 offen
    v_mov_b32 v80, 0
    v_mov_b32 v81, 0
    v_mov_b32 v82, 0
    v_mov_b32 v83, 0
    v_mov_b32 v84, 0
    v_mov_b32 v85, 0
    v_mov_b32 v86, 0
    v_mov_b32 v87, 0
    v_mov_b32 v88, 0
    v_mov_b32 v89, 0
    v_mov_b32 v90, 0
    v_mov_b32 v91, 0
    v_mov_b32 v92, 0
    v_mov_b32 v93, 0
    v_mov_b32 v94, 0
    v_mov_b32 v95, 0
    s_waitcnt vmcnt(3)
    ds_write_b128 v3, v[24:27] offset:0
    ds_write_b128 v3, v[28:31] offset:10240
    ds_write_b128 v3, v[32:35] offset:20480
    s_waitcnt lgkmcnt(0)
    s_barrier
    s_mov_b32 s53, 4
idft1_kernel_loop:
    s_add_u32 s39, s39, 262144
    s_add_u32 s52, s52, 128
    buffer_load_dwordx4 v[24:27], v10, s[28:31], s39 offen
    buffer_load_dwordx4 v[28:31], v11, s[28:31], s39 offen
    buffer_load_dwordx4 v[32:35], v12, s[32:35], s52 offen
    ds_read_b128 v[48:51], v20 offset:0
    ds_read_b128 v[52:55], v20 offset:2560
    ds_read_b128 v[56:59], v21 offset:0
    ds_read_b128 v[60:63], v21 offset:2560
    ds_read_b128 v[64:67], v20 offset:64
    ds_read_b128 v[68:71], v20 offset:2624
    ds_read_b128 v[72:75], v21 offset:64
    ds_read_b128 v[76:79], v21 offset:2624
    s_waitcnt vmcnt(3)
    ds_write_b128 v22, v[36:39] offset:0
    ds_write_b128 v22, v[40:43] offset:10240
    ds_write_b128 v22, v[44:47] offset:20480
    s_waitcnt lgkmcnt(7)
    v_mfma_f32_16x16x32_bf16 v[80:83], v[56:59], v[48:51], v[80:83]
    v_mfma_f32_16x16x32_bf16 v[84:87], v[60:63], v[48:51], v[84:87]
    v_mfma_f32_16x16x32_bf16 v[88:91], v[56:59], v[52:55], v[88:91]
    v_mfma_f32_16x16x32_bf16 v[92:95], v[60:63], v[52:55], v[92:95]
    s_waitcnt lgkmcnt(3)
    v_mfma_f32_16x16x32_bf16 v[80:83], v[72:75], v[64:67], v[80:83]
    v_mfma_f32_16x16x32_bf16 v[84:87], v[76:79], v[64:67], v[84:87]
    v_mfma_f32_16x16x32_bf16 v[88:91], v[72:75], v[68:71], v[88:91]
    v_mfma_f32_16x16x32_bf16 v[92:95], v[76:79], v[68:71], v[92:95]
    s_waitcnt lgkmcnt(0)
    s_barrier
    s_add_u32 s39, s39, 262144
    s_add_u32 s52, s52, 128
    buffer_load_dwordx4 v[36:39], v10, s[28:31], s39 offen
    buffer_load_dwordx4 v[40:43], v11, s[28:31], s39 offen
    buffer_load_dwordx4 v[44:47], v12, s[32:35], s52 offen
    ds_read_b128 v[48:51], v20 offset:30720
    ds_read_b128 v[52:55], v20 offset:33280
    ds_read_b128 v[56:59], v21 offset:30720
    ds_read_b128 v[60:63], v21 offset:33280
    ds_read_b128 v[64:67], v20 offset:30784
    ds_read_b128 v[68:71], v20 offset:33344
    ds_read_b128 v[72:75], v21 offset:30784
    ds_read_b128 v[76:79], v21 offset:33344
    s_waitcnt vmcnt(3)
    ds_write_b128 v3, v[24:27] offset:0
    ds_write_b128 v3, v[28:31] offset:10240
    ds_write_b128 v3, v[32:35] offset:20480
    s_waitcnt lgkmcnt(7)
    v_mfma_f32_16x16x32_bf16 v[80:83], v[56:59], v[48:51], v[80:83]
    v_mfma_f32_16x16x32_bf16 v[84:87], v[60:63], v[48:51], v[84:87]
    v_mfma_f32_16x16x32_bf16 v[88:91], v[56:59], v[52:55], v[88:91]
    v_mfma_f32_16x16x32_bf16 v[92:95], v[60:63], v[52:55], v[92:95]
    s_waitcnt lgkmcnt(3)
    v_mfma_f32_16x16x32_bf16 v[80:83], v[72:75], v[64:67], v[80:83]
    v_mfma_f32_16x16x32_bf16 v[84:87], v[76:79], v[64:67], v[84:87]
    v_mfma_f32_16x16x32_bf16 v[88:91], v[72:75], v[68:71], v[88:91]
    v_mfma_f32_16x16x32_bf16 v[92:95], v[76:79], v[68:71], v[92:95]
    s_waitcnt lgkmcnt(0)
    s_barrier
    s_sub_u32 s53, s53, 1
    s_cmp_lg_u32 s53, 0
    s_cbranch_scc1 idft1_kernel_loop
    s_add_u32 s39, s39, 262144
    s_add_u32 s52, s52, 128
    buffer_load_dwordx4 v[24:27], v10, s[28:31], s39 offen
    buffer_load_dwordx4 v[28:31], v11, s[28:31], s39 offen
    buffer_load_dwordx4 v[32:35], v12, s[32:35], s52 offen
    ds_read_b128 v[48:51], v20 offset:0
    ds_read_b128 v[52:55], v20 offset:2560
    ds_read_b128 v[56:59], v21 offset:0
    ds_read_b128 v[60:63], v21 offset:2560
    ds_read_b128 v[64:67], v20 offset:64
    ds_read_b128 v[68:71], v20 offset:2624
    ds_read_b128 v[72:75], v21 offset:64
    ds_read_b128 v[76:79], v21 offset:2624
    s_waitcnt vmcnt(3)
    ds_write_b128 v22, v[36:39] offset:0
    ds_write_b128 v22, v[40:43] offset:10240
    ds_write_b128 v22, v[44:47] offset:20480
    s_waitcnt lgkmcnt(7)
    v_mfma_f32_16x16x32_bf16 v[80:83], v[56:59], v[48:51], v[80:83]
    v_mfma_f32_16x16x32_bf16 v[84:87], v[60:63], v[48:51], v[84:87]
    v_mfma_f32_16x16x32_bf16 v[88:91], v[56:59], v[52:55], v[88:91]
    v_mfma_f32_16x16x32_bf16 v[92:95], v[60:63], v[52:55], v[92:95]
    s_waitcnt lgkmcnt(3)
    v_mfma_f32_16x16x32_bf16 v[80:83], v[72:75], v[64:67], v[80:83]
    v_mfma_f32_16x16x32_bf16 v[84:87], v[76:79], v[64:67], v[84:87]
    v_mfma_f32_16x16x32_bf16 v[88:91], v[72:75], v[68:71], v[88:91]
    v_mfma_f32_16x16x32_bf16 v[92:95], v[76:79], v[68:71], v[92:95]
    s_waitcnt lgkmcnt(0)
    s_barrier
    ds_read_b128 v[48:51], v20 offset:30720
    ds_read_b128 v[52:55], v20 offset:33280
    ds_read_b128 v[56:59], v21 offset:30720
    ds_read_b128 v[60:63], v21 offset:33280
    ds_read_b128 v[64:67], v20 offset:30784
    ds_read_b128 v[68:71], v20 offset:33344
    ds_read_b128 v[72:75], v21 offset:30784
    ds_read_b128 v[76:79], v21 offset:33344
    s_waitcnt vmcnt(0)
    ds_write_b128 v3, v[24:27] offset:0
    ds_write_b128 v3, v[28:31] offset:10240
    ds_write_b128 v3, v[32:35] offset:20480
    s_waitcnt lgkmcnt(7)
    v_mfma_f32_16x16x32_bf16 v[80:83], v[56:59], v[48:51], v[80:83]
    v_mfma_f32_16x16x32_bf16 v[84:87], v[60:63], v[48:51], v[84:87]
    v_mfma_f32_16x16x32_bf16 v[88:91], v[56:59], v[52:55], v[88:91]
    v_mfma_f32_16x16x32_bf16 v[92:95], v[60:63], v[52:55], v[92:95]
    s_waitcnt lgkmcnt(3)
    v_mfma_f32_16x16x32_bf16 v[80:83], v[72:75], v[64:67], v[80:83]
    v_mfma_f32_16x16x32_bf16 v[84:87], v[76:79], v[64:67], v[84:87]
    v_mfma_f32_16x16x32_bf16 v[88:91], v[72:75], v[68:71], v[88:91]
    v_mfma_f32_16x16x32_bf16 v[92:95], v[76:79], v[68:71], v[92:95]
    s_waitcnt lgkmcnt(0)
    s_barrier
    ds_read_b128 v[48:51], v20 offset:0
    ds_read_b128 v[52:55], v20 offset:2560
    ds_read_b128 v[56:59], v21 offset:0
    ds_read_b128 v[60:63], v21 offset:2560
    s_waitcnt lgkmcnt(0)
    v_mfma_f32_16x16x32_bf16 v[80:83], v[56:59], v[48:51], v[80:83]
    v_mfma_f32_16x16x32_bf16 v[84:87], v[60:63], v[48:51], v[84:87]
    v_mfma_f32_16x16x32_bf16 v[88:91], v[56:59], v[52:55], v[88:91]
    v_mfma_f32_16x16x32_bf16 v[92:95], v[60:63], v[52:55], v[92:95]
    s_nop 15
    s_mul_i32 s38, s37, 64
    v_mul_u32_u24 v9, 32, v8
    v_add_u32 v9, s38, v9
    v_lshlrev_b32 v1, 5, v7
    s_add_u32 s40, s24, 25165824
    s_addc_u32 s41, s25, 0
    s_mov_b32 s42, 8388608
    s_mov_b32 s43, 0x00020000
    v_lshl_add_u32 v9, v6, 2, v9
    v_add_u32 v1, v1, v5
    s_mul_i32 s38, s36, 128
    v_add_u32 v1, s38, v1
    s_mov_b32 s38, 1280
    v_mul_lo_u32 v2, v1, s38
    v_lshl_add_u32 v2, v9, 1, v2
    v_add_u32 v4, 20480, v2
    s_add_u32 s48, s24, 28311552
    s_addc_u32 s49, s25, 0
    s_mov_b32 s50, 2621440
    s_mov_b32 s51, 0x00020000
    buffer_load_dwordx2 v[40:41], v2, s[48:51], 0 offen offset:0
    buffer_load_dwordx2 v[42:43], v2, s[48:51], 0 offen offset:32
    buffer_load_dwordx2 v[44:45], v4, s[48:51], 0 offen offset:0
    buffer_load_dwordx2 v[46:47], v4, s[48:51], 0 offen offset:32
    s_waitcnt vmcnt(0)
    v_mul_f32 v80, 0x354ccccd, v80
    v_cvt_pk_bf16_f32 v80, v80, v80
    v_lshlrev_b32 v80, 16, v80
    v_lshlrev_b32 v10, 16, v40
    v_add_f32 v80, v80, v10
    v_mul_f32 v81, 0x354ccccd, v81
    v_cvt_pk_bf16_f32 v81, v81, v81
    v_lshlrev_b32 v81, 16, v81
    v_and_b32 v10, 0xffff0000, v40
    v_add_f32 v81, v81, v10
    v_mul_f32 v82, 0x354ccccd, v82
    v_cvt_pk_bf16_f32 v82, v82, v82
    v_lshlrev_b32 v82, 16, v82
    v_lshlrev_b32 v10, 16, v41
    v_add_f32 v82, v82, v10
    v_mul_f32 v83, 0x354ccccd, v83
    v_cvt_pk_bf16_f32 v83, v83, v83
    v_lshlrev_b32 v83, 16, v83
    v_and_b32 v10, 0xffff0000, v41
    v_add_f32 v83, v83, v10
    v_cvt_pk_bf16_f32 v80, v80, v81
    v_cvt_pk_bf16_f32 v81, v82, v83
    buffer_store_dwordx2 v[80:81], v2, s[40:43], 0 offen offset:0
    v_mul_f32 v84, 0x354ccccd, v84
    v_cvt_pk_bf16_f32 v84, v84, v84
    v_lshlrev_b32 v84, 16, v84
    v_lshlrev_b32 v10, 16, v42
    v_add_f32 v84, v84, v10
    v_mul_f32 v85, 0x354ccccd, v85
    v_cvt_pk_bf16_f32 v85, v85, v85
    v_lshlrev_b32 v85, 16, v85
    v_and_b32 v10, 0xffff0000, v42
    v_add_f32 v85, v85, v10
    v_mul_f32 v86, 0x354ccccd, v86
    v_cvt_pk_bf16_f32 v86, v86, v86
    v_lshlrev_b32 v86, 16, v86
    v_lshlrev_b32 v10, 16, v43
    v_add_f32 v86, v86, v10
    v_mul_f32 v87, 0x354ccccd, v87
    v_cvt_pk_bf16_f32 v87, v87, v87
    v_lshlrev_b32 v87, 16, v87
    v_and_b32 v10, 0xffff0000, v43
    v_add_f32 v87, v87, v10
    v_cvt_pk_bf16_f32 v84, v84, v85
    v_cvt_pk_bf16_f32 v85, v86, v87
    buffer_store_dwordx2 v[84:85], v2, s[40:43], 0 offen offset:32
    v_mul_f32 v88, 0x354ccccd, v88
    v_cvt_pk_bf16_f32 v88, v88, v88
    v_lshlrev_b32 v88, 16, v88
    v_lshlrev_b32 v10, 16, v44
    v_add_f32 v88, v88, v10
    v_mul_f32 v89, 0x354ccccd, v89
    v_cvt_pk_bf16_f32 v89, v89, v89
    v_lshlrev_b32 v89, 16, v89
    v_and_b32 v10, 0xffff0000, v44
    v_add_f32 v89, v89, v10
    v_mul_f32 v90, 0x354ccccd, v90
    v_cvt_pk_bf16_f32 v90, v90, v90
    v_lshlrev_b32 v90, 16, v90
    v_lshlrev_b32 v10, 16, v45
    v_add_f32 v90, v90, v10
    v_mul_f32 v91, 0x354ccccd, v91
    v_cvt_pk_bf16_f32 v91, v91, v91
    v_lshlrev_b32 v91, 16, v91
    v_and_b32 v10, 0xffff0000, v45
    v_add_f32 v91, v91, v10
    v_cvt_pk_bf16_f32 v88, v88, v89
    v_cvt_pk_bf16_f32 v89, v90, v91
    buffer_store_dwordx2 v[88:89], v4, s[40:43], 0 offen offset:0
    v_mul_f32 v92, 0x354ccccd, v92
    v_cvt_pk_bf16_f32 v92, v92, v92
    v_lshlrev_b32 v92, 16, v92
    v_lshlrev_b32 v10, 16, v46
    v_add_f32 v92, v92, v10
    v_mul_f32 v93, 0x354ccccd, v93
    v_cvt_pk_bf16_f32 v93, v93, v93
    v_lshlrev_b32 v93, 16, v93
    v_and_b32 v10, 0xffff0000, v46
    v_add_f32 v93, v93, v10
    v_mul_f32 v94, 0x354ccccd, v94
    v_cvt_pk_bf16_f32 v94, v94, v94
    v_lshlrev_b32 v94, 16, v94
    v_lshlrev_b32 v10, 16, v47
    v_add_f32 v94, v94, v10
    v_mul_f32 v95, 0x354ccccd, v95
    v_cvt_pk_bf16_f32 v95, v95, v95
    v_lshlrev_b32 v95, 16, v95
    v_and_b32 v10, 0xffff0000, v47
    v_add_f32 v95, v95, v10
    v_cvt_pk_bf16_f32 v92, v92, v93
    v_cvt_pk_bf16_f32 v93, v94, v95
    buffer_store_dwordx2 v[92:93], v4, s[40:43], 0 offen offset:32
idft1_kernel_end:
    s_endpgm
.section .rodata,"a"
.p2align 6
.amdhsa_kernel idft1_kernel
  .amdhsa_next_free_vgpr 96
  .amdhsa_next_free_sgpr 100
  .amdhsa_accum_offset 96
  .amdhsa_group_segment_fixed_size 0
  .amdhsa_kernarg_size 88
  .amdhsa_user_sgpr_count 2
  .amdhsa_user_sgpr_kernarg_segment_ptr 1
  .amdhsa_system_sgpr_workgroup_id_x 1
.end_amdhsa_kernel
.text
.globl g1_kernel
.p2align 8
.type g1_kernel,@function
g1_kernel:
    s_load_dwordx4 s[4:7], s[0:1], 0
    s_load_dwordx2 s[8:9], s[0:1], 16
    s_load_dwordx4 s[12:15], s[0:1], 32
    s_load_dwordx4 s[16:19], s[0:1], 48
    s_load_dwordx2 s[20:21], s[0:1], 64
    s_load_dwordx2 s[24:25], s[0:1], 80
    s_waitcnt lgkmcnt(0)
    s_cmp_ge_u32 s2, 432
    s_cbranch_scc1 g1_kernel_end
    s_and_b32 s36, s2, 15
    s_lshr_b32 s37, s2, 4
    s_add_u32 s28, s24, 7340032
    s_addc_u32 s29, s25, 0
    s_mov_b32 s30, 2621440
    s_mov_b32 s31, 0x00020000
    s_add_u32 s32, s24, 0
    s_addc_u32 s33, s25, 0
    s_mov_b32 s34, 2211840
    s_mov_b32 s35, 0x00020000
    v_lshrrev_b32 v1, 3, v0
    v_and_b32 v2, 7, v0
    s_mov_b32 s38, 16
    v_mul_lo_u32 v23, v2, s38
    v_lshlrev_b32 v2, 4, v2
    v_mul_u32_u24 v3, 160, v1
    v_add_u32 v3, v3, v2
    s_mul_i32 s38, s36, 128
    v_add_u32 v4, 0, v1
    v_add_u32 v4, s38, v4
    s_mov_b32 s38, 1280
    v_mul_lo_u32 v4, v4, s38
    v_add_u32 v10, v4, v23
    s_mul_i32 s38, s36, 128
    v_add_u32 v4, 64, v1
    v_add_u32 v4, s38, v4
    s_mov_b32 s38, 1280
    v_mul_lo_u32 v4, v4, s38
    v_add_u32 v11, v4, v23
    s_mul_i32 s38, s37, 64
    v_add_u32 v4, 0, v1
    v_add_u32 v4, s38, v4
    s_mov_b32 s38, 1280
    v_mul_lo_u32 v4, v4, s38
    v_add_u32 v12, v4, v2
    v_and_b32 v5, 15, v0
    v_bfe_u32 v6, v0, 4, 2
    v_bfe_u32 v7, v0, 6, 2
    v_lshrrev_b32 v8, 8, v0
    v_lshlrev_b32 v9, 5, v7
    v_add_u32 v9, v9, v5
    v_mul_u32_u24 v20, 160, v9
    v_lshl_add_u32 v20, v6, 4, v20
    v_mul_u32_u24 v9, 32, v8
    v_add_u32 v9, v9, v5
    v_add_u32 v9, 128, v9
    v_mul_u32_u24 v21, 160, v9
    v_lshl_add_u32 v21, v6, 4, v21
    v_add_u32 v22, 30720, v3
    s_mov_b32 s39, 0
    s_mov_b32 s52, 0
    buffer_load_dwordx4 v[24:27], v10, s[28:31], s39 offen
    buffer_load_dwordx4 v[28:31], v11, s[28:31], s39 offen
    buffer_load_dwordx4 v[32:35], v12, s[32:35], s52 offen
    s_add_u32 s39, s39, 128
    s_add_u32 s52, s52, 128
    buffer_load_dwordx4 v[36:39], v10, s[28:31], s39 offen
    buffer_load_dwordx4 v[40:43], v11, s[28:31], s39 offen
    buffer_load_dwordx4 v[44:47], v12, s[32:35], s52 offen
    v_mov_b32 v80, 0
    v_mov_b32 v81, 0
    v_mov_b32 v82, 0
    v_mov_b32 v83, 0
    v_mov_b32 v84, 0
    v_mov_b32 v85, 0
    v_mov_b32 v86, 0
    v_mov_b32 v87, 0
    v_mov_b32 v88, 0
    v_mov_b32 v89, 0
    v_mov_b32 v90, 0
    v_mov_b32 v91, 0
    v_mov_b32 v92, 0
    v_mov_b32 v93, 0
    v_mov_b32 v94, 0
    v_mov_b32 v95, 0
    s_waitcnt vmcnt(3)
    ds_write_b128 v3, v[24:27] offset:0
    ds_write_b128 v3, v[28:31] offset:10240
    ds_write_b128 v3, v[32:35] offset:20480
    s_waitcnt lgkmcnt(0)
    s_barrier
    s_mov_b32 s53, 4
g1_kernel_loop:
    s_add_u32 s39, s39, 128
    s_add_u32 s52, s52, 128
    buffer_load_dwordx4 v[24:27], v10, s[28:31], s39 offen
    buffer_load_dwordx4 v[28:31], v11, s[28:31], s39 offen
    buffer_load_dwordx4 v[32:35], v12, s[32:35], s52 offen
    ds_read_b128 v[48:51], v20 offset:0
    ds_read_b128 v[52:55], v20 offset:2560
    ds_read_b128 v[56:59], v21 offset:0
    ds_read_b128 v[60:63], v21 offset:2560
    ds_read_b128 v[64:67], v20 offset:64
    ds_read_b128 v[68:71], v20 offset:2624
    ds_read_b128 v[72:75], v21 offset:64
    ds_read_b128 v[76:79], v21 offset:2624
    s_waitcnt vmcnt(3)
    ds_write_b128 v22, v[36:39] offset:0
    ds_write_b128 v22, v[40:43] offset:10240
    ds_write_b128 v22, v[44:47] offset:20480
    s_waitcnt lgkmcnt(7)
    v_mfma_f32_16x16x32_bf16 v[80:83], v[56:59], v[48:51], v[80:83]
    v_mfma_f32_16x16x32_bf16 v[84:87], v[60:63], v[48:51], v[84:87]
    v_mfma_f32_16x16x32_bf16 v[88:91], v[56:59], v[52:55], v[88:91]
    v_mfma_f32_16x16x32_bf16 v[92:95], v[60:63], v[52:55], v[92:95]
    s_waitcnt lgkmcnt(3)
    v_mfma_f32_16x16x32_bf16 v[80:83], v[72:75], v[64:67], v[80:83]
    v_mfma_f32_16x16x32_bf16 v[84:87], v[76:79], v[64:67], v[84:87]
    v_mfma_f32_16x16x32_bf16 v[88:91], v[72:75], v[68:71], v[88:91]
    v_mfma_f32_16x16x32_bf16 v[92:95], v[76:79], v[68:71], v[92:95]
    s_waitcnt lgkmcnt(0)
    s_barrier
    s_add_u32 s39, s39, 128
    s_add_u32 s52, s52, 128
    buffer_load_dwordx4 v[36:39], v10, s[28:31], s39 offen
    buffer_load_dwordx4 v[40:43], v11, s[28:31], s39 offen
    buffer_load_dwordx4 v[44:47], v12, s[32:35], s52 offen
    ds_read_b128 v[48:51], v20 offset:30720
    ds_read_b128 v[52:55], v20 offset:33280
    ds_read_b128 v[56:59], v21 offset:30720
    ds_read_b128 v[60:63], v21 offset:33280
    ds_read_b128 v[64:67], v20 offset:30784
    ds_read_b128 v[68:71], v20 offset:33344
    ds_read_b128 v[72:75], v21 offset:30784
    ds_read_b128 v[76:79], v21 offset:33344
    s_waitcnt vmcnt(3)
    ds_write_b128 v3, v[24:27] offset:0
    ds_write_b128 v3, v[28:31] offset:10240
    ds_write_b128 v3, v[32:35] offset:20480
    s_waitcnt lgkmcnt(7)
    v_mfma_f32_16x16x32_bf16 v[80:83], v[56:59], v[48:51], v[80:83]
    v_mfma_f32_16x16x32_bf16 v[84:87], v[60:63], v[48:51], v[84:87]
    v_mfma_f32_16x16x32_bf16 v[88:91], v[56:59], v[52:55], v[88:91]
    v_mfma_f32_16x16x32_bf16 v[92:95], v[60:63], v[52:55], v[92:95]
    s_waitcnt lgkmcnt(3)
    v_mfma_f32_16x16x32_bf16 v[80:83], v[72:75], v[64:67], v[80:83]
    v_mfma_f32_16x16x32_bf16 v[84:87], v[76:79], v[64:67], v[84:87]
    v_mfma_f32_16x16x32_bf16 v[88:91], v[72:75], v[68:71], v[88:91]
    v_mfma_f32_16x16x32_bf16 v[92:95], v[76:79], v[68:71], v[92:95]
    s_waitcnt lgkmcnt(0)
    s_barrier
    s_sub_u32 s53, s53, 1
    s_cmp_lg_u32 s53, 0
    s_cbranch_scc1 g1_kernel_loop
    ds_read_b128 v[48:51], v20 offset:0
    ds_read_b128 v[52:55], v20 offset:2560
    ds_read_b128 v[56:59], v21 offset:0
    ds_read_b128 v[60:63], v21 offset:2560
    ds_read_b128 v[64:67], v20 offset:64
    ds_read_b128 v[68:71], v20 offset:2624
    ds_read_b128 v[72:75], v21 offset:64
    ds_read_b128 v[76:79], v21 offset:2624
    s_waitcnt vmcnt(0)
    ds_write_b128 v22, v[36:39] offset:0
    ds_write_b128 v22, v[40:43] offset:10240
    ds_write_b128 v22, v[44:47] offset:20480
    s_waitcnt lgkmcnt(7)
    v_mfma_f32_16x16x32_bf16 v[80:83], v[56:59], v[48:51], v[80:83]
    v_mfma_f32_16x16x32_bf16 v[84:87], v[60:63], v[48:51], v[84:87]
    v_mfma_f32_16x16x32_bf16 v[88:91], v[56:59], v[52:55], v[88:91]
    v_mfma_f32_16x16x32_bf16 v[92:95], v[60:63], v[52:55], v[92:95]
    s_waitcnt lgkmcnt(3)
    v_mfma_f32_16x16x32_bf16 v[80:83], v[72:75], v[64:67], v[80:83]
    v_mfma_f32_16x16x32_bf16 v[84:87], v[76:79], v[64:67], v[84:87]
    v_mfma_f32_16x16x32_bf16 v[88:91], v[72:75], v[68:71], v[88:91]
    v_mfma_f32_16x16x32_bf16 v[92:95], v[76:79], v[68:71], v[92:95]
    s_waitcnt lgkmcnt(0)
    s_barrier
    ds_read_b128 v[48:51], v20 offset:30720
    ds_read_b128 v[52:55], v20 offset:33280
    ds_read_b128 v[56:59], v21 offset:30720
    ds_read_b128 v[60:63], v21 offset:33280
    ds_read_b128 v[64:67], v20 offset:30784
    ds_read_b128 v[68:71], v20 offset:33344
    ds_read_b128 v[72:75], v21 offset:30784
    ds_read_b128 v[76:79], v21 offset:33344
    s_waitcnt lgkmcnt(4)
    v_mfma_f32_16x16x32_bf16 v[80:83], v[56:59], v[48:51], v[80:83]
    v_mfma_f32_16x16x32_bf16 v[84:87], v[60:63], v[48:51], v[84:87]
    v_mfma_f32_16x16x32_bf16 v[88:91], v[56:59], v[52:55], v[88:91]
    v_mfma_f32_16x16x32_bf16 v[92:95], v[60:63], v[52:55], v[92:95]
    s_waitcnt lgkmcnt(0)
    v_mfma_f32_16x16x32_bf16 v[80:83], v[72:75], v[64:67], v[80:83]
    v_mfma_f32_16x16x32_bf16 v[84:87], v[76:79], v[64:67], v[84:87]
    v_mfma_f32_16x16x32_bf16 v[88:91], v[72:75], v[68:71], v[88:91]
    v_mfma_f32_16x16x32_bf16 v[92:95], v[76:79], v[68:71], v[92:95]
    s_nop 15
    s_mul_i32 s38, s37, 64
    v_mul_u32_u24 v9, 32, v8
    v_add_u32 v9, s38, v9
    v_lshlrev_b32 v1, 5, v7
    s_add_u32 s40, s24, 16777216
    s_addc_u32 s41, s25, 0
    s_mov_b32 s42, 8388608
    s_mov_b32 s43, 0x00020000
    v_lshl_add_u32 v9, v6, 2, v9
    v_add_u32 v1, v1, v5
    s_mul_i32 s38, s36, 128
    v_add_u32 v1, s38, v1
    s_mov_b32 s38, 3456
    v_mul_lo_u32 v2, v1, s38
    v_lshl_add_u32 v2, v9, 1, v2
    v_add_u32 v4, 55296, v2
    s_add_u32 s44, s14, 0
    s_addc_u32 s45, s15, 0
    s_mov_b32 s46, 3456
    s_mov_b32 s47, 0x00020000
    v_lshlrev_b32 v3, 1, v9
    buffer_load_dwordx2 v[24:25], v3, s[44:47], 0 offen offset:0
    buffer_load_dwordx2 v[26:27], v3, s[44:47], 0 offen offset:32
    s_waitcnt vmcnt(0)
    v_cvt_pk_bf16_f32 v80, v80, v80
    v_lshlrev_b32 v80, 16, v80
    v_lshlrev_b32 v10, 16, v24
    v_add_f32 v80, v80, v10
    v_cvt_pk_bf16_f32 v80, v80, v80
    v_lshlrev_b32 v80, 16, v80
    v_mul_f32 v10, v80, v80
    v_mul_f32 v10, 0x3d372713, v10
    v_fma_f32 v10, v10, v80, v80
    v_mul_f32 v10, 0xc0135761, v10
    v_exp_f32 v10, v10
    s_nop 0
    v_add_f32 v10, 1.0, v10
    v_rcp_f32 v10, v10
    s_nop 0
    v_mul_f32 v80, v80, v10
    v_cvt_pk_bf16_f32 v81, v81, v81
    v_lshlrev_b32 v81, 16, v81
    v_and_b32 v10, 0xffff0000, v24
    v_add_f32 v81, v81, v10
    v_cvt_pk_bf16_f32 v81, v81, v81
    v_lshlrev_b32 v81, 16, v81
    v_mul_f32 v10, v81, v81
    v_mul_f32 v10, 0x3d372713, v10
    v_fma_f32 v10, v10, v81, v81
    v_mul_f32 v10, 0xc0135761, v10
    v_exp_f32 v10, v10
    s_nop 0
    v_add_f32 v10, 1.0, v10
    v_rcp_f32 v10, v10
    s_nop 0
    v_mul_f32 v81, v81, v10
    v_cvt_pk_bf16_f32 v82, v82, v82
    v_lshlrev_b32 v82, 16, v82
    v_lshlrev_b32 v10, 16, v25
    v_add_f32 v82, v82, v10
    v_cvt_pk_bf16_f32 v82, v82, v82
    v_lshlrev_b32 v82, 16, v82
    v_mul_f32 v10, v82, v82
    v_mul_f32 v10, 0x3d372713, v10
    v_fma_f32 v10, v10, v82, v82
    v_mul_f32 v10, 0xc0135761, v10
    v_exp_f32 v10, v10
    s_nop 0
    v_add_f32 v10, 1.0, v10
    v_rcp_f32 v10, v10
    s_nop 0
    v_mul_f32 v82, v82, v10
    v_cvt_pk_bf16_f32 v83, v83, v83
    v_lshlrev_b32 v83, 16, v83
    v_and_b32 v10, 0xffff0000, v25
    v_add_f32 v83, v83, v10
    v_cvt_pk_bf16_f32 v83, v83, v83
    v_lshlrev_b32 v83, 16, v83
    v_mul_f32 v10, v83, v83
    v_mul_f32 v10, 0x3d372713, v10
    v_fma_f32 v10, v10, v83, v83
    v_mul_f32 v10, 0xc0135761, v10
    v_exp_f32 v10, v10
    s_nop 0
    v_add_f32 v10, 1.0, v10
    v_rcp_f32 v10, v10
    s_nop 0
    v_mul_f32 v83, v83, v10
    v_cvt_pk_bf16_f32 v80, v80, v81
    v_cvt_pk_bf16_f32 v81, v82, v83
    buffer_store_dwordx2 v[80:81], v2, s[40:43], 0 offen offset:0
    v_cvt_pk_bf16_f32 v84, v84, v84
    v_lshlrev_b32 v84, 16, v84
    v_lshlrev_b32 v10, 16, v26
    v_add_f32 v84, v84, v10
    v_cvt_pk_bf16_f32 v84, v84, v84
    v_lshlrev_b32 v84, 16, v84
    v_mul_f32 v10, v84, v84
    v_mul_f32 v10, 0x3d372713, v10
    v_fma_f32 v10, v10, v84, v84
    v_mul_f32 v10, 0xc0135761, v10
    v_exp_f32 v10, v10
    s_nop 0
    v_add_f32 v10, 1.0, v10
    v_rcp_f32 v10, v10
    s_nop 0
    v_mul_f32 v84, v84, v10
    v_cvt_pk_bf16_f32 v85, v85, v85
    v_lshlrev_b32 v85, 16, v85
    v_and_b32 v10, 0xffff0000, v26
    v_add_f32 v85, v85, v10
    v_cvt_pk_bf16_f32 v85, v85, v85
    v_lshlrev_b32 v85, 16, v85
    v_mul_f32 v10, v85, v85
    v_mul_f32 v10, 0x3d372713, v10
    v_fma_f32 v10, v10, v85, v85
    v_mul_f32 v10, 0xc0135761, v10
    v_exp_f32 v10, v10
    s_nop 0
    v_add_f32 v10, 1.0, v10
    v_rcp_f32 v10, v10
    s_nop 0
    v_mul_f32 v85, v85, v10
    v_cvt_pk_bf16_f32 v86, v86, v86
    v_lshlrev_b32 v86, 16, v86
    v_lshlrev_b32 v10, 16, v27
    v_add_f32 v86, v86, v10
    v_cvt_pk_bf16_f32 v86, v86, v86
    v_lshlrev_b32 v86, 16, v86
    v_mul_f32 v10, v86, v86
    v_mul_f32 v10, 0x3d372713, v10
    v_fma_f32 v10, v10, v86, v86
    v_mul_f32 v10, 0xc0135761, v10
    v_exp_f32 v10, v10
    s_nop 0
    v_add_f32 v10, 1.0, v10
    v_rcp_f32 v10, v10
    s_nop 0
    v_mul_f32 v86, v86, v10
    v_cvt_pk_bf16_f32 v87, v87, v87
    v_lshlrev_b32 v87, 16, v87
    v_and_b32 v10, 0xffff0000, v27
    v_add_f32 v87, v87, v10
    v_cvt_pk_bf16_f32 v87, v87, v87
    v_lshlrev_b32 v87, 16, v87
    v_mul_f32 v10, v87, v87
    v_mul_f32 v10, 0x3d372713, v10
    v_fma_f32 v10, v10, v87, v87
    v_mul_f32 v10, 0xc0135761, v10
    v_exp_f32 v10, v10
    s_nop 0
    v_add_f32 v10, 1.0, v10
    v_rcp_f32 v10, v10
    s_nop 0
    v_mul_f32 v87, v87, v10
    v_cvt_pk_bf16_f32 v84, v84, v85
    v_cvt_pk_bf16_f32 v85, v86, v87
    buffer_store_dwordx2 v[84:85], v2, s[40:43], 0 offen offset:32
    v_cvt_pk_bf16_f32 v88, v88, v88
    v_lshlrev_b32 v88, 16, v88
    v_lshlrev_b32 v10, 16, v24
    v_add_f32 v88, v88, v10
    v_cvt_pk_bf16_f32 v88, v88, v88
    v_lshlrev_b32 v88, 16, v88
    v_mul_f32 v10, v88, v88
    v_mul_f32 v10, 0x3d372713, v10
    v_fma_f32 v10, v10, v88, v88
    v_mul_f32 v10, 0xc0135761, v10
    v_exp_f32 v10, v10
    s_nop 0
    v_add_f32 v10, 1.0, v10
    v_rcp_f32 v10, v10
    s_nop 0
    v_mul_f32 v88, v88, v10
    v_cvt_pk_bf16_f32 v89, v89, v89
    v_lshlrev_b32 v89, 16, v89
    v_and_b32 v10, 0xffff0000, v24
    v_add_f32 v89, v89, v10
    v_cvt_pk_bf16_f32 v89, v89, v89
    v_lshlrev_b32 v89, 16, v89
    v_mul_f32 v10, v89, v89
    v_mul_f32 v10, 0x3d372713, v10
    v_fma_f32 v10, v10, v89, v89
    v_mul_f32 v10, 0xc0135761, v10
    v_exp_f32 v10, v10
    s_nop 0
    v_add_f32 v10, 1.0, v10
    v_rcp_f32 v10, v10
    s_nop 0
    v_mul_f32 v89, v89, v10
    v_cvt_pk_bf16_f32 v90, v90, v90
    v_lshlrev_b32 v90, 16, v90
    v_lshlrev_b32 v10, 16, v25
    v_add_f32 v90, v90, v10
    v_cvt_pk_bf16_f32 v90, v90, v90
    v_lshlrev_b32 v90, 16, v90
    v_mul_f32 v10, v90, v90
    v_mul_f32 v10, 0x3d372713, v10
    v_fma_f32 v10, v10, v90, v90
    v_mul_f32 v10, 0xc0135761, v10
    v_exp_f32 v10, v10
    s_nop 0
    v_add_f32 v10, 1.0, v10
    v_rcp_f32 v10, v10
    s_nop 0
    v_mul_f32 v90, v90, v10
    v_cvt_pk_bf16_f32 v91, v91, v91
    v_lshlrev_b32 v91, 16, v91
    v_and_b32 v10, 0xffff0000, v25
    v_add_f32 v91, v91, v10
    v_cvt_pk_bf16_f32 v91, v91, v91
    v_lshlrev_b32 v91, 16, v91
    v_mul_f32 v10, v91, v91
    v_mul_f32 v10, 0x3d372713, v10
    v_fma_f32 v10, v10, v91, v91
    v_mul_f32 v10, 0xc0135761, v10
    v_exp_f32 v10, v10
    s_nop 0
    v_add_f32 v10, 1.0, v10
    v_rcp_f32 v10, v10
    s_nop 0
    v_mul_f32 v91, v91, v10
    v_cvt_pk_bf16_f32 v88, v88, v89
    v_cvt_pk_bf16_f32 v89, v90, v91
    buffer_store_dwordx2 v[88:89], v4, s[40:43], 0 offen offset:0
    v_cvt_pk_bf16_f32 v92, v92, v92
    v_lshlrev_b32 v92, 16, v92
    v_lshlrev_b32 v10, 16, v26
    v_add_f32 v92, v92, v10
    v_cvt_pk_bf16_f32 v92, v92, v92
    v_lshlrev_b32 v92, 16, v92
    v_mul_f32 v10, v92, v92
    v_mul_f32 v10, 0x3d372713, v10
    v_fma_f32 v10, v10, v92, v92
    v_mul_f32 v10, 0xc0135761, v10
    v_exp_f32 v10, v10
    s_nop 0
    v_add_f32 v10, 1.0, v10
    v_rcp_f32 v10, v10
    s_nop 0
    v_mul_f32 v92, v92, v10
    v_cvt_pk_bf16_f32 v93, v93, v93
    v_lshlrev_b32 v93, 16, v93
    v_and_b32 v10, 0xffff0000, v26
    v_add_f32 v93, v93, v10
    v_cvt_pk_bf16_f32 v93, v93, v93
    v_lshlrev_b32 v93, 16, v93
    v_mul_f32 v10, v93, v93
    v_mul_f32 v10, 0x3d372713, v10
    v_fma_f32 v10, v10, v93, v93
    v_mul_f32 v10, 0xc0135761, v10
    v_exp_f32 v10, v10
    s_nop 0
    v_add_f32 v10, 1.0, v10
    v_rcp_f32 v10, v10
    s_nop 0
    v_mul_f32 v93, v93, v10
    v_cvt_pk_bf16_f32 v94, v94, v94
    v_lshlrev_b32 v94, 16, v94
    v_lshlrev_b32 v10, 16, v27
    v_add_f32 v94, v94, v10
    v_cvt_pk_bf16_f32 v94, v94, v94
    v_lshlrev_b32 v94, 16, v94
    v_mul_f32 v10, v94, v94
    v_mul_f32 v10, 0x3d372713, v10
    v_fma_f32 v10, v10, v94, v94
    v_mul_f32 v10, 0xc0135761, v10
    v_exp_f32 v10, v10
    s_nop 0
    v_add_f32 v10, 1.0, v10
    v_rcp_f32 v10, v10
    s_nop 0
    v_mul_f32 v94, v94, v10
    v_cvt_pk_bf16_f32 v95, v95, v95
    v_lshlrev_b32 v95, 16, v95
    v_and_b32 v10, 0xffff0000, v27
    v_add_f32 v95, v95, v10
    v_cvt_pk_bf16_f32 v95, v95, v95
    v_lshlrev_b32 v95, 16, v95
    v_mul_f32 v10, v95, v95
    v_mul_f32 v10, 0x3d372713, v10
    v_fma_f32 v10, v10, v95, v95
    v_mul_f32 v10, 0xc0135761, v10
    v_exp_f32 v10, v10
    s_nop 0
    v_add_f32 v10, 1.0, v10
    v_rcp_f32 v10, v10
    s_nop 0
    v_mul_f32 v95, v95, v10
    v_cvt_pk_bf16_f32 v92, v92, v93
    v_cvt_pk_bf16_f32 v93, v94, v95
    buffer_store_dwordx2 v[92:93], v4, s[40:43], 0 offen offset:32
g1_kernel_end:
    s_endpgm
.section .rodata,"a"
.p2align 6
.amdhsa_kernel g1_kernel
  .amdhsa_next_free_vgpr 96
  .amdhsa_next_free_sgpr 100
  .amdhsa_accum_offset 96
  .amdhsa_group_segment_fixed_size 0
  .amdhsa_kernarg_size 88
  .amdhsa_user_sgpr_count 2
  .amdhsa_user_sgpr_kernarg_segment_ptr 1
  .amdhsa_system_sgpr_workgroup_id_x 1
.end_amdhsa_kernel
.text
.globl g2a_kernel
.p2align 8
.type g2a_kernel,@function
g2a_kernel:
    s_load_dwordx4 s[4:7], s[0:1], 0
    s_load_dwordx2 s[8:9], s[0:1], 16
    s_load_dwordx4 s[12:15], s[0:1], 32
    s_load_dwordx4 s[16:19], s[0:1], 48
    s_load_dwordx2 s[20:21], s[0:1], 64
    s_load_dwordx2 s[24:25], s[0:1], 80
    s_waitcnt lgkmcnt(0)
    s_cmp_ge_u32 s2, 160
    s_cbranch_scc1 g2a_kernel_end
    s_and_b32 s36, s2, 15
    s_lshr_b32 s37, s2, 4
    s_add_u32 s28, s24, 16777216
    s_addc_u32 s29, s25, 0
    s_mov_b32 s30, 7077888
    s_mov_b32 s31, 0x00020000
    s_add_u32 s32, s24, 2228224
    s_addc_u32 s33, s25, 0
    s_mov_b32 s34, 2211840
    s_mov_b32 s35, 0x00020000
    v_lshrrev_b32 v1, 3, v0
    v_and_b32 v2, 7, v0
    s_mov_b32 s38, 16
    v_mul_lo_u32 v23, v2, s38
    v_lshlrev_b32 v2, 4, v2
    v_mul_u32_u24 v3, 160, v1
    v_add_u32 v3, v3, v2
    s_mul_i32 s38, s36, 128
    v_add_u32 v4, 0, v1
    v_add_u32 v4, s38, v4
    s_mov_b32 s38, 3456
    v_mul_lo_u32 v4, v4, s38
    v_add_u32 v10, v4, v23
    s_mul_i32 s38, s36, 128
    v_add_u32 v4, 64, v1
    v_add_u32 v4, s38, v4
    s_mov_b32 s38, 3456
    v_mul_lo_u32 v4, v4, s38
    v_add_u32 v11, v4, v23
    s_mul_i32 s38, s37, 64
    v_add_u32 v4, 0, v1
    v_add_u32 v4, s38, v4
    s_mov_b32 s38, 3456
    v_mul_lo_u32 v4, v4, s38
    v_add_u32 v12, v4, v2
    v_and_b32 v5, 15, v0
    v_bfe_u32 v6, v0, 4, 2
    v_bfe_u32 v7, v0, 6, 2
    v_lshrrev_b32 v8, 8, v0
    v_lshlrev_b32 v9, 5, v7
    v_add_u32 v9, v9, v5
    v_mul_u32_u24 v20, 160, v9
    v_lshl_add_u32 v20, v6, 4, v20
    v_mul_u32_u24 v9, 32, v8
    v_add_u32 v9, v9, v5
    v_add_u32 v9, 128, v9
    v_mul_u32_u24 v21, 160, v9
    v_lshl_add_u32 v21, v6, 4, v21
    v_add_u32 v22, 30720, v3
    s_mov_b32 s39, 0
    s_mov_b32 s52, 0
    buffer_load_dwordx4 v[24:27], v10, s[28:31], s39 offen
    buffer_load_dwordx4 v[28:31], v11, s[28:31], s39 offen
    buffer_load_dwordx4 v[32:35], v12, s[32:35], s52 offen
    s_add_u32 s39, s39, 128
    s_add_u32 s52, s52, 128
    buffer_load_dwordx4 v[36:39], v10, s[28:31], s39 offen
    buffer_load_dwordx4 v[40:43], v11, s[28:31], s39 offen
    buffer_load_dwordx4 v[44:47], v12, s[32:35], s52 offen
    v_mov_b32 v80, 0
    v_mov_b32 v81, 0
    v_mov_b32 v82, 0
    v_mov_b32 v83, 0
    v_mov_b32 v84, 0
    v_mov_b32 v85, 0
    v_mov_b32 v86, 0
    v_mov_b32 v87, 0
    v_mov_b32 v88, 0
    v_mov_b32 v89, 0
    v_mov_b32 v90, 0
    v_mov_b32 v91, 0
    v_mov_b32 v92, 0
    v_mov_b32 v93, 0
    v_mov_b32 v94, 0
    v_mov_b32 v95, 0
    s_waitcnt vmcnt(3)
    ds_write_b128 v3, v[24:27] offset:0
    ds_write_b128 v3, v[28:31] offset:10240
    ds_write_b128 v3, v[32:35] offset:20480
    s_waitcnt lgkmcnt(0)
    s_barrier
    s_mov_b32 s53, 12
g2a_kernel_loop:
    s_add_u32 s39, s39, 128
    s_add_u32 s52, s52, 128
    buffer_load_dwordx4 v[24:27], v10, s[28:31], s39 offen
    buffer_load_dwordx4 v[28:31], v11, s[28:31], s39 offen
    buffer_load_dwordx4 v[32:35], v12, s[32:35], s52 offen
    ds_read_b128 v[48:51], v20 offset:0
    ds_read_b128 v[52:55], v20 offset:2560
    ds_read_b128 v[56:59], v21 offset:0
    ds_read_b128 v[60:63], v21 offset:2560
    ds_read_b128 v[64:67], v20 offset:64
    ds_read_b128 v[68:71], v20 offset:2624
    ds_read_b128 v[72:75], v21 offset:64
    ds_read_b128 v[76:79], v21 offset:2624
    s_waitcnt vmcnt(3)
    ds_write_b128 v22, v[36:39] offset:0
    ds_write_b128 v22, v[40:43] offset:10240
    ds_write_b128 v22, v[44:47] offset:20480
    s_waitcnt lgkmcnt(7)
    v_mfma_f32_16x16x32_bf16 v[80:83], v[56:59], v[48:51], v[80:83]
    v_mfma_f32_16x16x32_bf16 v[84:87], v[60:63], v[48:51], v[84:87]
    v_mfma_f32_16x16x32_bf16 v[88:91], v[56:59], v[52:55], v[88:91]
    v_mfma_f32_16x16x32_bf16 v[92:95], v[60:63], v[52:55], v[92:95]
    s_waitcnt lgkmcnt(3)
    v_mfma_f32_16x16x32_bf16 v[80:83], v[72:75], v[64:67], v[80:83]
    v_mfma_f32_16x16x32_bf16 v[84:87], v[76:79], v[64:67], v[84:87]
    v_mfma_f32_16x16x32_bf16 v[88:91], v[72:75], v[68:71], v[88:91]
    v_mfma_f32_16x16x32_bf16 v[92:95], v[76:79], v[68:71], v[92:95]
    s_waitcnt lgkmcnt(0)
    s_barrier
    s_add_u32 s39, s39, 128
    s_add_u32 s52, s52, 128
    buffer_load_dwordx4 v[36:39], v10, s[28:31], s39 offen
    buffer_load_dwordx4 v[40:43], v11, s[28:31], s39 offen
    buffer_load_dwordx4 v[44:47], v12, s[32:35], s52 offen
    ds_read_b128 v[48:51], v20 offset:30720
    ds_read_b128 v[52:55], v20 offset:33280
    ds_read_b128 v[56:59], v21 offset:30720
    ds_read_b128 v[60:63], v21 offset:33280
    ds_read_b128 v[64:67], v20 offset:30784
    ds_read_b128 v[68:71], v20 offset:33344
    ds_read_b128 v[72:75], v21 offset:30784
    ds_read_b128 v[76:79], v21 offset:33344
    s_waitcnt vmcnt(3)
    ds_write_b128 v3, v[24:27] offset:0
    ds_write_b128 v3, v[28:31] offset:10240
    ds_write_b128 v3, v[32:35] offset:20480
    s_waitcnt lgkmcnt(7)
    v_mfma_f32_16x16x32_bf16 v[80:83], v[56:59], v[48:51], v[80:83]
    v_mfma_f32_16x16x32_bf16 v[84:87], v[60:63], v[48:51], v[84:87]
    v_mfma_f32_16x16x32_bf16 v[88:91], v[56:59], v[52:55], v[88:91]
    v_mfma_f32_16x16x32_bf16 v[92:95], v[60:63], v[52:55], v[92:95]
    s_waitcnt lgkmcnt(3)
    v_mfma_f32_16x16x32_bf16 v[80:83], v[72:75], v[64:67], v[80:83]
    v_mfma_f32_16x16x32_bf16 v[84:87], v[76:79], v[64:67], v[84:87]
    v_mfma_f32_16x16x32_bf16 v[88:91], v[72:75], v[68:71], v[88:91]
    v_mfma_f32_16x16x32_bf16 v[92:95], v[76:79], v[68:71], v[92:95]
    s_waitcnt lgkmcnt(0)
    s_barrier
    s_sub_u32 s53, s53, 1
    s_cmp_lg_u32 s53, 0
    s_cbranch_scc1 g2a_kernel_loop
    s_add_u32 s39, s39, 128
    s_add_u32 s52, s52, 128
    buffer_load_dwordx4 v[24:27], v10, s[28:31], s39 offen
    buffer_load_dwordx4 v[28:31], v11, s[28:31], s39 offen
    buffer_load_dwordx4 v[32:35], v12, s[32:35], s52 offen
    ds_read_b128 v[48:51], v20 offset:0
    ds_read_b128 v[52:55], v20 offset:2560
    ds_read_b128 v[56:59], v21 offset:0
    ds_read_b128 v[60:63], v21 offset:2560
    ds_read_b128 v[64:67], v20 offset:64
    ds_read_b128 v[68:71], v20 offset:2624
    ds_read_b128 v[72:75], v21 offset:64
    ds_read_b128 v[76:79], v21 offset:2624
    s_waitcnt vmcnt(3)
    ds_write_b128 v22, v[36:39] offset:0
    ds_write_b128 v22, v[40:43] offset:10240
    ds_write_b128 v22, v[44:47] offset:20480
    s_waitcnt lgkmcnt(7)
    v_mfma_f32_16x16x32_bf16 v[80:83], v[56:59], v[48:51], v[80:83]
    v_mfma_f32_16x16x32_bf16 v[84:87], v[60:63], v[48:51], v[84:87]
    v_mfma_f32_16x16x32_bf16 v[88:91], v[56:59], v[52:55], v[88:91]
    v_mfma_f32_16x16x32_bf16 v[92:95], v[60:63], v[52:55], v[92:95]
    s_waitcnt lgkmcnt(3)
    v_mfma_f32_16x16x32_bf16 v[80:83], v[72:75], v[64:67], v[80:83]
    v_mfma_f32_16x16x32_bf16 v[84:87], v[76:79], v[64:67], v[84:87]
    v_mfma_f32_16x16x32_bf16 v[88:91], v[72:75], v[68:71], v[88:91]
    v_mfma_f32_16x16x32_bf16 v[92:95], v[76:79], v[68:71], v[92:95]
    s_waitcnt lgkmcnt(0)
    s_barrier
    ds_read_b128 v[48:51], v20 offset:30720
    ds_read_b128 v[52:55], v20 offset:33280
    ds_read_b128 v[56:59], v21 offset:30720
    ds_read_b128 v[60:63], v21 offset:33280
    ds_read_b128 v[64:67], v20 offset:30784
    ds_read_b128 v[68:71], v20 offset:33344
    ds_read_b128 v[72:75], v21 offset:30784
    ds_read_b128 v[76:79], v21 offset:33344
    s_waitcnt vmcnt(0)
    ds_write_b128 v3, v[24:27] offset:0
    ds_write_b128 v3, v[28:31] offset:10240
    ds_write_b128 v3, v[32:35] offset:20480
    s_waitcnt lgkmcnt(7)
    v_mfma_f32_16x16x32_bf16 v[80:83], v[56:59], v[48:51], v[80:83]
    v_mfma_f32_16x16x32_bf16 v[84:87], v[60:63], v[48:51], v[84:87]
    v_mfma_f32_16x16x32_bf16 v[88:91], v[56:59], v[52:55], v[88:91]
    v_mfma_f32_16x16x32_bf16 v[92:95], v[60:63], v[52:55], v[92:95]
    s_waitcnt lgkmcnt(3)
    v_mfma_f32_16x16x32_bf16 v[80:83], v[72:75], v[64:67], v[80:83]
    v_mfma_f32_16x16x32_bf16 v[84:87], v[76:79], v[64:67], v[84:87]
    v_mfma_f32_16x16x32_bf16 v[88:91], v[72:75], v[68:71], v[88:91]
    v_mfma_f32_16x16x32_bf16 v[92:95], v[76:79], v[68:71], v[92:95]
    s_waitcnt lgkmcnt(0)
    s_barrier
    ds_read_b128 v[48:51], v20 offset:0
    ds_read_b128 v[52:55], v20 offset:2560
    ds_read_b128 v[56:59], v21 offset:0
    ds_read_b128 v[60:63], v21 offset:2560
    ds_read_b128 v[64:67], v20 offset:64
    ds_read_b128 v[68:71], v20 offset:2624
    ds_read_b128 v[72:75], v21 offset:64
    ds_read_b128 v[76:79], v21 offset:2624
    s_waitcnt lgkmcnt(4)
    v_mfma_f32_16x16x32_bf16 v[80:83], v[56:59], v[48:51], v[80:83]
    v_mfma_f32_16x16x32_bf16 v[84:87], v[60:63], v[48:51], v[84:87]
    v_mfma_f32_16x16x32_bf16 v[88:91], v[56:59], v[52:55], v[88:91]
    v_mfma_f32_16x16x32_bf16 v[92:95], v[60:63], v[52:55], v[92:95]
    s_waitcnt lgkmcnt(0)
    v_mfma_f32_16x16x32_bf16 v[80:83], v[72:75], v[64:67], v[80:83]
    v_mfma_f32_16x16x32_bf16 v[84:87], v[76:79], v[64:67], v[84:87]
    v_mfma_f32_16x16x32_bf16 v[88:91], v[72:75], v[68:71], v[88:91]
    v_mfma_f32_16x16x32_bf16 v[92:95], v[76:79], v[68:71], v[92:95]
    s_nop 15
    s_mul_i32 s38, s37, 64
    v_mul_u32_u24 v9, 32, v8
    v_add_u32 v9, s38, v9
    v_lshlrev_b32 v1, 5, v7
    s_add_u32 s40, s24, 28311552
    s_addc_u32 s41, s25, 0
    s_mov_b32 s42, 8388608
    s_mov_b32 s43, 0x00020000
    v_lshl_add_u32 v9, v6, 2, v9
    v_add_u32 v1, v1, v5
    s_mul_i32 s38, s36, 128
    v_add_u32 v1, s38, v1
    s_mov_b32 s38, 1280
    v_mul_lo_u32 v2, v1, s38
    v_lshl_add_u32 v2, v9, 1, v2
    v_add_u32 v4, 20480, v2
    s_add_u32 s44, s18, 0
    s_addc_u32 s45, s19, 0
    s_mov_b32 s46, 1280
    s_mov_b32 s47, 0x00020000
    v_lshlrev_b32 v3, 1, v9
    buffer_load_dwordx2 v[24:25], v3, s[44:47], 0 offen offset:0
    buffer_load_dwordx2 v[26:27], v3, s[44:47], 0 offen offset:32
    s_add_u32 s48, s24, 25165824
    s_addc_u32 s49, s25, 0
    s_mov_b32 s50, 2621440
    s_mov_b32 s51, 0x00020000
    buffer_load_dwordx2 v[40:41], v2, s[48:51], 0 offen offset:0
    buffer_load_dwordx2 v[42:43], v2, s[48:51], 0 offen offset:32
    buffer_load_dwordx2 v[44:45], v4, s[48:51], 0 offen offset:0
    buffer_load_dwordx2 v[46:47], v4, s[48:51], 0 offen offset:32
    s_waitcnt vmcnt(0)
    v_cvt_pk_bf16_f32 v80, v80, v80
    v_lshlrev_b32 v80, 16, v80
    v_lshlrev_b32 v10, 16, v24
    v_add_f32 v80, v80, v10
    v_cvt_pk_bf16_f32 v80, v80, v80
    v_lshlrev_b32 v80, 16, v80
    v_lshlrev_b32 v10, 16, v40
    v_add_f32 v80, v80, v10
    v_cvt_pk_bf16_f32 v81, v81, v81
    v_lshlrev_b32 v81, 16, v81
    v_and_b32 v10, 0xffff0000, v24
    v_add_f32 v81, v81, v10
    v_cvt_pk_bf16_f32 v81, v81, v81
    v_lshlrev_b32 v81, 16, v81
    v_and_b32 v10, 0xffff0000, v40
    v_add_f32 v81, v81, v10
    v_cvt_pk_bf16_f32 v82, v82, v82
    v_lshlrev_b32 v82, 16, v82
    v_lshlrev_b32 v10, 16, v25
    v_add_f32 v82, v82, v10
    v_cvt_pk_bf16_f32 v82, v82, v82
    v_lshlrev_b32 v82, 16, v82
    v_lshlrev_b32 v10, 16, v41
    v_add_f32 v82, v82, v10
    v_cvt_pk_bf16_f32 v83, v83, v83
    v_lshlrev_b32 v83, 16, v83
    v_and_b32 v10, 0xffff0000, v25
    v_add_f32 v83, v83, v10
    v_cvt_pk_bf16_f32 v83, v83, v83
    v_lshlrev_b32 v83, 16, v83
    v_and_b32 v10, 0xffff0000, v41
    v_add_f32 v83, v83, v10
    v_cvt_pk_bf16_f32 v80, v80, v81
    v_cvt_pk_bf16_f32 v81, v82, v83
    buffer_store_dwordx2 v[80:81], v2, s[40:43], 0 offen offset:0
    v_cvt_pk_bf16_f32 v84, v84, v84
    v_lshlrev_b32 v84, 16, v84
    v_lshlrev_b32 v10, 16, v26
    v_add_f32 v84, v84, v10
    v_cvt_pk_bf16_f32 v84, v84, v84
    v_lshlrev_b32 v84, 16, v84
    v_lshlrev_b32 v10, 16, v42
    v_add_f32 v84, v84, v10
    v_cvt_pk_bf16_f32 v85, v85, v85
    v_lshlrev_b32 v85, 16, v85
    v_and_b32 v10, 0xffff0000, v26
    v_add_f32 v85, v85, v10
    v_cvt_pk_bf16_f32 v85, v85, v85
    v_lshlrev_b32 v85, 16, v85
    v_and_b32 v10, 0xffff0000, v42
    v_add_f32 v85, v85, v10
    v_cvt_pk_bf16_f32 v86, v86, v86
    v_lshlrev_b32 v86, 16, v86
    v_lshlrev_b32 v10, 16, v27
    v_add_f32 v86, v86, v10
    v_cvt_pk_bf16_f32 v86, v86, v86
    v_lshlrev_b32 v86, 16, v86
    v_lshlrev_b32 v10, 16, v43
    v_add_f32 v86, v86, v10
    v_cvt_pk_bf16_f32 v87, v87, v87
    v_lshlrev_b32 v87, 16, v87
    v_and_b32 v10, 0xffff0000, v27
    v_add_f32 v87, v87, v10
    v_cvt_pk_bf16_f32 v87, v87, v87
    v_lshlrev_b32 v87, 16, v87
    v_and_b32 v10, 0xffff0000, v43
    v_add_f32 v87, v87, v10
    v_cvt_pk_bf16_f32 v84, v84, v85
    v_cvt_pk_bf16_f32 v85, v86, v87
    buffer_store_dwordx2 v[84:85], v2, s[40:43], 0 offen offset:32
    v_cvt_pk_bf16_f32 v88, v88, v88
    v_lshlrev_b32 v88, 16, v88
    v_lshlrev_b32 v10, 16, v24
    v_add_f32 v88, v88, v10
    v_cvt_pk_bf16_f32 v88, v88, v88
    v_lshlrev_b32 v88, 16, v88
    v_lshlrev_b32 v10, 16, v44
    v_add_f32 v88, v88, v10
    v_cvt_pk_bf16_f32 v89, v89, v89
    v_lshlrev_b32 v89, 16, v89
    v_and_b32 v10, 0xffff0000, v24
    v_add_f32 v89, v89, v10
    v_cvt_pk_bf16_f32 v89, v89, v89
    v_lshlrev_b32 v89, 16, v89
    v_and_b32 v10, 0xffff0000, v44
    v_add_f32 v89, v89, v10
    v_cvt_pk_bf16_f32 v90, v90, v90
    v_lshlrev_b32 v90, 16, v90
    v_lshlrev_b32 v10, 16, v25
    v_add_f32 v90, v90, v10
    v_cvt_pk_bf16_f32 v90, v90, v90
    v_lshlrev_b32 v90, 16, v90
    v_lshlrev_b32 v10, 16, v45
    v_add_f32 v90, v90, v10
    v_cvt_pk_bf16_f32 v91, v91, v91
    v_lshlrev_b32 v91, 16, v91
    v_and_b32 v10, 0xffff0000, v25
    v_add_f32 v91, v91, v10
    v_cvt_pk_bf16_f32 v91, v91, v91
    v_lshlrev_b32 v91, 16, v91
    v_and_b32 v10, 0xffff0000, v45
    v_add_f32 v91, v91, v10
    v_cvt_pk_bf16_f32 v88, v88, v89
    v_cvt_pk_bf16_f32 v89, v90, v91
    buffer_store_dwordx2 v[88:89], v4, s[40:43], 0 offen offset:0
    v_cvt_pk_bf16_f32 v92, v92, v92
    v_lshlrev_b32 v92, 16, v92
    v_lshlrev_b32 v10, 16, v26
    v_add_f32 v92, v92, v10
    v_cvt_pk_bf16_f32 v92, v92, v92
    v_lshlrev_b32 v92, 16, v92
    v_lshlrev_b32 v10, 16, v46
    v_add_f32 v92, v92, v10
    v_cvt_pk_bf16_f32 v93, v93, v93
    v_lshlrev_b32 v93, 16, v93
    v_and_b32 v10, 0xffff0000, v26
    v_add_f32 v93, v93, v10
    v_cvt_pk_bf16_f32 v93, v93, v93
    v_lshlrev_b32 v93, 16, v93
    v_and_b32 v10, 0xffff0000, v46
    v_add_f32 v93, v93, v10
    v_cvt_pk_bf16_f32 v94, v94, v94
    v_lshlrev_b32 v94, 16, v94
    v_lshlrev_b32 v10, 16, v27
    v_add_f32 v94, v94, v10
    v_cvt_pk_bf16_f32 v94, v94, v94
    v_lshlrev_b32 v94, 16, v94
    v_lshlrev_b32 v10, 16, v47
    v_add_f32 v94, v94, v10
    v_cvt_pk_bf16_f32 v95, v95, v95
    v_lshlrev_b32 v95, 16, v95
    v_and_b32 v10, 0xffff0000, v27
    v_add_f32 v95, v95, v10
    v_cvt_pk_bf16_f32 v95, v95, v95
    v_lshlrev_b32 v95, 16, v95
    v_and_b32 v10, 0xffff0000, v47
    v_add_f32 v95, v95, v10
    v_cvt_pk_bf16_f32 v92, v92, v93
    v_cvt_pk_bf16_f32 v93, v94, v95
    buffer_store_dwordx2 v[92:93], v4, s[40:43], 0 offen offset:32
g2a_kernel_end:
    s_endpgm
.section .rodata,"a"
.p2align 6
.amdhsa_kernel g2a_kernel
  .amdhsa_next_free_vgpr 96
  .amdhsa_next_free_sgpr 100
  .amdhsa_accum_offset 96
  .amdhsa_group_segment_fixed_size 0
  .amdhsa_kernarg_size 88
  .amdhsa_user_sgpr_count 2
  .amdhsa_user_sgpr_kernarg_segment_ptr 1
  .amdhsa_system_sgpr_workgroup_id_x 1
.end_amdhsa_kernel
.text
.globl g2b_kernel
.p2align 8
.type g2b_kernel,@function
g2b_kernel:
    s_load_dwordx4 s[4:7], s[0:1], 0
    s_load_dwordx2 s[8:9], s[0:1], 16
    s_load_dwordx4 s[12:15], s[0:1], 32
    s_load_dwordx4 s[16:19], s[0:1], 48
    s_load_dwordx2 s[20:21], s[0:1], 64
    s_load_dwordx2 s[24:25], s[0:1], 80
    s_waitcnt lgkmcnt(0)
    s_cmp_ge_u32 s2, 160
    s_cbranch_scc1 g2b_kernel_end
    s_and_b32 s36, s2, 15
    s_lshr_b32 s37, s2, 4
    s_add_u32 s28, s24, 16777216
    s_addc_u32 s29, s25, 0
    s_mov_b32 s30, 7077888
    s_mov_b32 s31, 0x00020000
    s_add_u32 s32, s24, 2228224
    s_addc_u32 s33, s25, 0
    s_mov_b32 s34, 2211840
    s_mov_b32 s35, 0x00020000
    v_lshrrev_b32 v1, 3, v0
    v_and_b32 v2, 7, v0
    s_mov_b32 s38, 16
    v_mul_lo_u32 v23, v2, s38
    v_lshlrev_b32 v2, 4, v2
    v_mul_u32_u24 v3, 160, v1
    v_add_u32 v3, v3, v2
    s_mul_i32 s38, s36, 128
    v_add_u32 v4, 0, v1
    v_add_u32 v4, s38, v4
    s_mov_b32 s38, 3456
    v_mul_lo_u32 v4, v4, s38
    v_add_u32 v10, v4, v23
    s_mul_i32 s38, s36, 128
    v_add_u32 v4, 64, v1
    v_add_u32 v4, s38, v4
    s_mov_b32 s38, 3456
    v_mul_lo_u32 v4, v4, s38
    v_add_u32 v11, v4, v23
    s_mul_i32 s38, s37, 64
    v_add_u32 v4, 0, v1
    v_add_u32 v4, s38, v4
    s_mov_b32 s38, 3456
    v_mul_lo_u32 v4, v4, s38
    v_add_u32 v12, v4, v2
    v_and_b32 v5, 15, v0
    v_bfe_u32 v6, v0, 4, 2
    v_bfe_u32 v7, v0, 6, 2
    v_lshrrev_b32 v8, 8, v0
    v_lshlrev_b32 v9, 5, v7
    v_add_u32 v9, v9, v5
    v_mul_u32_u24 v20, 160, v9
    v_lshl_add_u32 v20, v6, 4, v20
    v_mul_u32_u24 v9, 32, v8
    v_add_u32 v9, v9, v5
    v_add_u32 v9, 128, v9
    v_mul_u32_u24 v21, 160, v9
    v_lshl_add_u32 v21, v6, 4, v21
    v_add_u32 v22, 30720, v3
    s_mov_b32 s39, 0
    s_mov_b32 s52, 0
    buffer_load_dwordx4 v[24:27], v10, s[28:31], s39 offen
    buffer_load_dwordx4 v[28:31], v11, s[28:31], s39 offen
    buffer_load_dwordx4 v[32:35], v12, s[32:35], s52 offen
    s_add_u32 s39, s39, 128
    s_add_u32 s52, s52, 128
    buffer_load_dwordx4 v[36:39], v10, s[28:31], s39 offen
    buffer_load_dwordx4 v[40:43], v11, s[28:31], s39 offen
    buffer_load_dwordx4 v[44:47], v12, s[32:35], s52 offen
    v_mov_b32 v80, 0
    v_mov_b32 v81, 0
    v_mov_b32 v82, 0
    v_mov_b32 v83, 0
    v_mov_b32 v84, 0
    v_mov_b32 v85, 0
    v_mov_b32 v86, 0
    v_mov_b32 v87, 0
    v_mov_b32 v88, 0
    v_mov_b32 v89, 0
    v_mov_b32 v90, 0
    v_mov_b32 v91, 0
    v_mov_b32 v92, 0
    v_mov_b32 v93, 0
    v_mov_b32 v94, 0
    v_mov_b32 v95, 0
    s_waitcnt vmcnt(3)
    ds_write_b128 v3, v[24:27] offset:0
    ds_write_b128 v3, v[28:31] offset:10240
    ds_write_b128 v3, v[32:35] offset:20480
    s_waitcnt lgkmcnt(0)
    s_barrier
    s_mov_b32 s53, 12
g2b_kernel_loop:
    s_add_u32 s39, s39, 128
    s_add_u32 s52, s52, 128
    buffer_load_dwordx4 v[24:27], v10, s[28:31], s39 offen
    buffer_load_dwordx4 v[28:31], v11, s[28:31], s39 offen
    buffer_load_dwordx4 v[32:35], v12, s[32:35], s52 offen
    ds_read_b128 v[48:51], v20 offset:0
    ds_read_b128 v[52:55], v20 offset:2560
    ds_read_b128 v[56:59], v21 offset:0
    ds_read_b128 v[60:63], v21 offset:2560
    ds_read_b128 v[64:67], v20 offset:64
    ds_read_b128 v[68:71], v20 offset:2624
    ds_read_b128 v[72:75], v21 offset:64
    ds_read_b128 v[76:79], v21 offset:2624
    s_waitcnt vmcnt(3)
    ds_write_b128 v22, v[36:39] offset:0
    ds_write_b128 v22, v[40:43] offset:10240
    ds_write_b128 v22, v[44:47] offset:20480
    s_waitcnt lgkmcnt(7)
    v_mfma_f32_16x16x32_bf16 v[80:83], v[56:59], v[48:51], v[80:83]
    v_mfma_f32_16x16x32_bf16 v[84:87], v[60:63], v[48:51], v[84:87]
    v_mfma_f32_16x16x32_bf16 v[88:91], v[56:59], v[52:55], v[88:91]
    v_mfma_f32_16x16x32_bf16 v[92:95], v[60:63], v[52:55], v[92:95]
    s_waitcnt lgkmcnt(3)
    v_mfma_f32_16x16x32_bf16 v[80:83], v[72:75], v[64:67], v[80:83]
    v_mfma_f32_16x16x32_bf16 v[84:87], v[76:79], v[64:67], v[84:87]
    v_mfma_f32_16x16x32_bf16 v[88:91], v[72:75], v[68:71], v[88:91]
    v_mfma_f32_16x16x32_bf16 v[92:95], v[76:79], v[68:71], v[92:95]
    s_waitcnt lgkmcnt(0)
    s_barrier
    s_add_u32 s39, s39, 128
    s_add_u32 s52, s52, 128
    buffer_load_dwordx4 v[36:39], v10, s[28:31], s39 offen
    buffer_load_dwordx4 v[40:43], v11, s[28:31], s39 offen
    buffer_load_dwordx4 v[44:47], v12, s[32:35], s52 offen
    ds_read_b128 v[48:51], v20 offset:30720
    ds_read_b128 v[52:55], v20 offset:33280
    ds_read_b128 v[56:59], v21 offset:30720
    ds_read_b128 v[60:63], v21 offset:33280
    ds_read_b128 v[64:67], v20 offset:30784
    ds_read_b128 v[68:71], v20 offset:33344
    ds_read_b128 v[72:75], v21 offset:30784
    ds_read_b128 v[76:79], v21 offset:33344
    s_waitcnt vmcnt(3)
    ds_write_b128 v3, v[24:27] offset:0
    ds_write_b128 v3, v[28:31] offset:10240
    ds_write_b128 v3, v[32:35] offset:20480
    s_waitcnt lgkmcnt(7)
    v_mfma_f32_16x16x32_bf16 v[80:83], v[56:59], v[48:51], v[80:83]
    v_mfma_f32_16x16x32_bf16 v[84:87], v[60:63], v[48:51], v[84:87]
    v_mfma_f32_16x16x32_bf16 v[88:91], v[56:59], v[52:55], v[88:91]
    v_mfma_f32_16x16x32_bf16 v[92:95], v[60:63], v[52:55], v[92:95]
    s_waitcnt lgkmcnt(3)
    v_mfma_f32_16x16x32_bf16 v[80:83], v[72:75], v[64:67], v[80:83]
    v_mfma_f32_16x16x32_bf16 v[84:87], v[76:79], v[64:67], v[84:87]
    v_mfma_f32_16x16x32_bf16 v[88:91], v[72:75], v[68:71], v[88:91]
    v_mfma_f32_16x16x32_bf16 v[92:95], v[76:79], v[68:71], v[92:95]
    s_waitcnt lgkmcnt(0)
    s_barrier
    s_sub_u32 s53, s53, 1
    s_cmp_lg_u32 s53, 0
    s_cbranch_scc1 g2b_kernel_loop
    s_add_u32 s39, s39, 128
    s_add_u32 s52, s52, 128
    buffer_load_dwordx4 v[24:27], v10, s[28:31], s39 offen
    buffer_load_dwordx4 v[28:31], v11, s[28:31], s39 offen
    buffer_load_dwordx4 v[32:35], v12, s[32:35], s52 offen
    ds_read_b128 v[48:51], v20 offset:0
    ds_read_b128 v[52:55], v20 offset:2560
    ds_read_b128 v[56:59], v21 offset:0
    ds_read_b128 v[60:63], v21 offset:2560
    ds_read_b128 v[64:67], v20 offset:64
    ds_read_b128 v[68:71], v20 offset:2624
    ds_read_b128 v[72:75], v21 offset:64
    ds_read_b128 v[76:79], v21 offset:2624
    s_waitcnt vmcnt(3)
    ds_write_b128 v22, v[36:39] offset:0
    ds_write_b128 v22, v[40:43] offset:10240
    ds_write_b128 v22, v[44:47] offset:20480
    s_waitcnt lgkmcnt(7)
    v_mfma_f32_16x16x32_bf16 v[80:83], v[56:59], v[48:51], v[80:83]
    v_mfma_f32_16x16x32_bf16 v[84:87], v[60:63], v[48:51], v[84:87]
    v_mfma_f32_16x16x32_bf16 v[88:91], v[56:59], v[52:55], v[88:91]
    v_mfma_f32_16x16x32_bf16 v[92:95], v[60:63], v[52:55], v[92:95]
    s_waitcnt lgkmcnt(3)
    v_mfma_f32_16x16x32_bf16 v[80:83], v[72:75], v[64:67], v[80:83]
    v_mfma_f32_16x16x32_bf16 v[84:87], v[76:79], v[64:67], v[84:87]
    v_mfma_f32_16x16x32_bf16 v[88:91], v[72:75], v[68:71], v[88:91]
    v_mfma_f32_16x16x32_bf16 v[92:95], v[76:79], v[68:71], v[92:95]
    s_waitcnt lgkmcnt(0)
    s_barrier
    ds_read_b128 v[48:51], v20 offset:30720
    ds_read_b128 v[52:55], v20 offset:33280
    ds_read_b128 v[56:59], v21 offset:30720
    ds_read_b128 v[60:63], v21 offset:33280
    ds_read_b128 v[64:67], v20 offset:30784
    ds_read_b128 v[68:71], v20 offset:33344
    ds_read_b128 v[72:75], v21 offset:30784
    ds_read_b128 v[76:79], v21 offset:33344
    s_waitcnt vmcnt(0)
    ds_write_b128 v3, v[24:27] offset:0
    ds_write_b128 v3, v[28:31] offset:10240
    ds_write_b128 v3, v[32:35] offset:20480
    s_waitcnt lgkmcnt(7)
    v_mfma_f32_16x16x32_bf16 v[80:83], v[56:59], v[48:51], v[80:83]
    v_mfma_f32_16x16x32_bf16 v[84:87], v[60:63], v[48:51], v[84:87]
    v_mfma_f32_16x16x32_bf16 v[88:91], v[56:59], v[52:55], v[88:91]
    v_mfma_f32_16x16x32_bf16 v[92:95], v[60:63], v[52:55], v[92:95]
    s_waitcnt lgkmcnt(3)
    v_mfma_f32_16x16x32_bf16 v[80:83], v[72:75], v[64:67], v[80:83]
    v_mfma_f32_16x16x32_bf16 v[84:87], v[76:79], v[64:67], v[84:87]
    v_mfma_f32_16x16x32_bf16 v[88:91], v[72:75], v[68:71], v[88:91]
    v_mfma_f32_16x16x32_bf16 v[92:95], v[76:79], v[68:71], v[92:95]
    s_waitcnt lgkmcnt(0)
    s_barrier
    ds_read_b128 v[48:51], v20 offset:0
    ds_read_b128 v[52:55], v20 offset:2560
    ds_read_b128 v[56:59], v21 offset:0
    ds_read_b128 v[60:63], v21 offset:2560
    ds_read_b128 v[64:67], v20 offset:64
    ds_read_b128 v[68:71], v20 offset:2624
    ds_read_b128 v[72:75], v21 offset:64
    ds_read_b128 v[76:79], v21 offset:2624
    s_waitcnt lgkmcnt(4)
    v_mfma_f32_16x16x32_bf16 v[80:83], v[56:59], v[48:51], v[80:83]
    v_mfma_f32_16x16x32_bf16 v[84:87], v[60:63], v[48:51], v[84:87]
    v_mfma_f32_16x16x32_bf16 v[88:91], v[56:59], v[52:55], v[88:91]
    v_mfma_f32_16x16x32_bf16 v[92:95], v[60:63], v[52:55], v[92:95]
    s_waitcnt lgkmcnt(0)
    v_mfma_f32_16x16x32_bf16 v[80:83], v[72:75], v[64:67], v[80:83]
    v_mfma_f32_16x16x32_bf16 v[84:87], v[76:79], v[64:67], v[84:87]
    v_mfma_f32_16x16x32_bf16 v[88:91], v[72:75], v[68:71], v[88:91]
    v_mfma_f32_16x16x32_bf16 v[92:95], v[76:79], v[68:71], v[92:95]
    s_nop 15
    s_mul_i32 s38, s37, 64
    v_mul_u32_u24 v9, 32, v8
    v_add_u32 v9, s38, v9
    v_lshlrev_b32 v1, 5, v7
    s_add_u32 s40, s20, 0
    s_addc_u32 s41, s21, 0
    s_mov_b32 s42, 8388608
    s_mov_b32 s43, 0x00020000
    v_lshl_add_u32 v9, v6, 2, v9
    v_add_u32 v1, v1, v5
    s_mul_i32 s38, s36, 128
    v_add_u32 v1, s38, v1
    s_mov_b32 s38, 1280
    v_mul_lo_u32 v2, v1, s38
    v_lshl_add_u32 v2, v9, 1, v2
    v_add_u32 v4, 20480, v2
    s_add_u32 s44, s18, 0
    s_addc_u32 s45, s19, 0
    s_mov_b32 s46, 1280
    s_mov_b32 s47, 0x00020000
    v_lshlrev_b32 v3, 1, v9
    buffer_load_dwordx2 v[24:25], v3, s[44:47], 0 offen offset:0
    buffer_load_dwordx2 v[26:27], v3, s[44:47], 0 offen offset:32
    s_add_u32 s48, s24, 25165824
    s_addc_u32 s49, s25, 0
    s_mov_b32 s50, 2621440
    s_mov_b32 s51, 0x00020000
    buffer_load_dwordx2 v[40:41], v2, s[48:51], 0 offen offset:0
    buffer_load_dwordx2 v[42:43], v2, s[48:51], 0 offen offset:32
    buffer_load_dwordx2 v[44:45], v4, s[48:51], 0 offen offset:0
    buffer_load_dwordx2 v[46:47], v4, s[48:51], 0 offen offset:32
    s_waitcnt vmcnt(0)
    v_cvt_pk_bf16_f32 v80, v80, v80
    v_lshlrev_b32 v80, 16, v80
    v_lshlrev_b32 v10, 16, v24
    v_add_f32 v80, v80, v10
    v_cvt_pk_bf16_f32 v80, v80, v80
    v_lshlrev_b32 v80, 16, v80
    v_lshlrev_b32 v10, 16, v40
    v_add_f32 v80, v80, v10
    v_cvt_pk_bf16_f32 v81, v81, v81
    v_lshlrev_b32 v81, 16, v81
    v_and_b32 v10, 0xffff0000, v24
    v_add_f32 v81, v81, v10
    v_cvt_pk_bf16_f32 v81, v81, v81
    v_lshlrev_b32 v81, 16, v81
    v_and_b32 v10, 0xffff0000, v40
    v_add_f32 v81, v81, v10
    v_cvt_pk_bf16_f32 v82, v82, v82
    v_lshlrev_b32 v82, 16, v82
    v_lshlrev_b32 v10, 16, v25
    v_add_f32 v82, v82, v10
    v_cvt_pk_bf16_f32 v82, v82, v82
    v_lshlrev_b32 v82, 16, v82
    v_lshlrev_b32 v10, 16, v41
    v_add_f32 v82, v82, v10
    v_cvt_pk_bf16_f32 v83, v83, v83
    v_lshlrev_b32 v83, 16, v83
    v_and_b32 v10, 0xffff0000, v25
    v_add_f32 v83, v83, v10
    v_cvt_pk_bf16_f32 v83, v83, v83
    v_lshlrev_b32 v83, 16, v83
    v_and_b32 v10, 0xffff0000, v41
    v_add_f32 v83, v83, v10
    v_cvt_pk_bf16_f32 v80, v80, v81
    v_cvt_pk_bf16_f32 v81, v82, v83
    buffer_store_dwordx2 v[80:81], v2, s[40:43], 0 offen offset:0
    v_cvt_pk_bf16_f32 v84, v84, v84
    v_lshlrev_b32 v84, 16, v84
    v_lshlrev_b32 v10, 16, v26
    v_add_f32 v84, v84, v10
    v_cvt_pk_bf16_f32 v84, v84, v84
    v_lshlrev_b32 v84, 16, v84
    v_lshlrev_b32 v10, 16, v42
    v_add_f32 v84, v84, v10
    v_cvt_pk_bf16_f32 v85, v85, v85
    v_lshlrev_b32 v85, 16, v85
    v_and_b32 v10, 0xffff0000, v26
    v_add_f32 v85, v85, v10
    v_cvt_pk_bf16_f32 v85, v85, v85
    v_lshlrev_b32 v85, 16, v85
    v_and_b32 v10, 0xffff0000, v42
    v_add_f32 v85, v85, v10
    v_cvt_pk_bf16_f32 v86, v86, v86
    v_lshlrev_b32 v86, 16, v86
    v_lshlrev_b32 v10, 16, v27
    v_add_f32 v86, v86, v10
    v_cvt_pk_bf16_f32 v86, v86, v86
    v_lshlrev_b32 v86, 16, v86
    v_lshlrev_b32 v10, 16, v43
    v_add_f32 v86, v86, v10
    v_cvt_pk_bf16_f32 v87, v87, v87
    v_lshlrev_b32 v87, 16, v87
    v_and_b32 v10, 0xffff0000, v27
    v_add_f32 v87, v87, v10
    v_cvt_pk_bf16_f32 v87, v87, v87
    v_lshlrev_b32 v87, 16, v87
    v_and_b32 v10, 0xffff0000, v43
    v_add_f32 v87, v87, v10
    v_cvt_pk_bf16_f32 v84, v84, v85
    v_cvt_pk_bf16_f32 v85, v86, v87
    buffer_store_dwordx2 v[84:85], v2, s[40:43], 0 offen offset:32
    v_cvt_pk_bf16_f32 v88, v88, v88
    v_lshlrev_b32 v88, 16, v88
    v_lshlrev_b32 v10, 16, v24
    v_add_f32 v88, v88, v10
    v_cvt_pk_bf16_f32 v88, v88, v88
    v_lshlrev_b32 v88, 16, v88
    v_lshlrev_b32 v10, 16, v44
    v_add_f32 v88, v88, v10
    v_cvt_pk_bf16_f32 v89, v89, v89
    v_lshlrev_b32 v89, 16, v89
    v_and_b32 v10, 0xffff0000, v24
    v_add_f32 v89, v89, v10
    v_cvt_pk_bf16_f32 v89, v89, v89
    v_lshlrev_b32 v89, 16, v89
    v_and_b32 v10, 0xffff0000, v44
    v_add_f32 v89, v89, v10
    v_cvt_pk_bf16_f32 v90, v90, v90
    v_lshlrev_b32 v90, 16, v90
    v_lshlrev_b32 v10, 16, v25
    v_add_f32 v90, v90, v10
    v_cvt_pk_bf16_f32 v90, v90, v90
    v_lshlrev_b32 v90, 16, v90
    v_lshlrev_b32 v10, 16, v45
    v_add_f32 v90, v90, v10
    v_cvt_pk_bf16_f32 v91, v91, v91
    v_lshlrev_b32 v91, 16, v91
    v_and_b32 v10, 0xffff0000, v25
    v_add_f32 v91, v91, v10
    v_cvt_pk_bf16_f32 v91, v91, v91
    v_lshlrev_b32 v91, 16, v91
    v_and_b32 v10, 0xffff0000, v45
    v_add_f32 v91, v91, v10
    v_cvt_pk_bf16_f32 v88, v88, v89
    v_cvt_pk_bf16_f32 v89, v90, v91
    buffer_store_dwordx2 v[88:89], v4, s[40:43], 0 offen offset:0
    v_cvt_pk_bf16_f32 v92, v92, v92
    v_lshlrev_b32 v92, 16, v92
    v_lshlrev_b32 v10, 16, v26
    v_add_f32 v92, v92, v10
    v_cvt_pk_bf16_f32 v92, v92, v92
    v_lshlrev_b32 v92, 16, v92
    v_lshlrev_b32 v10, 16, v46
    v_add_f32 v92, v92, v10
    v_cvt_pk_bf16_f32 v93, v93, v93
    v_lshlrev_b32 v93, 16, v93
    v_and_b32 v10, 0xffff0000, v26
    v_add_f32 v93, v93, v10
    v_cvt_pk_bf16_f32 v93, v93, v93
    v_lshlrev_b32 v93, 16, v93
    v_and_b32 v10, 0xffff0000, v46
    v_add_f32 v93, v93, v10
    v_cvt_pk_bf16_f32 v94, v94, v94
    v_lshlrev_b32 v94, 16, v94
    v_lshlrev_b32 v10, 16, v27
    v_add_f32 v94, v94, v10
    v_cvt_pk_bf16_f32 v94, v94, v94
    v_lshlrev_b32 v94, 16, v94
    v_lshlrev_b32 v10, 16, v47
    v_add_f32 v94, v94, v10
    v_cvt_pk_bf16_f32 v95, v95, v95
    v_lshlrev_b32 v95, 16, v95
    v_and_b32 v10, 0xffff0000, v27
    v_add_f32 v95, v95, v10
    v_cvt_pk_bf16_f32 v95, v95, v95
    v_lshlrev_b32 v95, 16, v95
    v_and_b32 v10, 0xffff0000, v47
    v_add_f32 v95, v95, v10
    v_cvt_pk_bf16_f32 v92, v92, v93
    v_cvt_pk_bf16_f32 v93, v94, v95
    buffer_store_dwordx2 v[92:93], v4, s[40:43], 0 offen offset:32
g2b_kernel_end:
    s_endpgm
.section .rodata,"a"
.p2align 6
.amdhsa_kernel g2b_kernel
  .amdhsa_next_free_vgpr 96
  .amdhsa_next_free_sgpr 100
  .amdhsa_accum_offset 96
  .amdhsa_group_segment_fixed_size 0
  .amdhsa_kernarg_size 88
  .amdhsa_user_sgpr_count 2
  .amdhsa_user_sgpr_kernarg_segment_ptr 1
  .amdhsa_system_sgpr_workgroup_id_x 1
.end_amdhsa_kernel
```
